```python
import torch

def _softmax(x, axis=-1):
    return torch.softmax(x, dim=axis)
def _gelu(x):
    return torch.nn.functional.gelu(x, approximate="tanh")
def _silu(x):
    return torch.nn.functional.silu(x)
def _sigmoid(x):
    return torch.sigmoid(x)
def _layernorm(x, axis=-1, eps=1e-5):
    m = x.mean(dim=axis, keepdim=True)
    v = x.var(dim=axis, keepdim=True, unbiased=False)
    return (x - m) / torch.sqrt(v + eps)
def _scatter_add(tgt, idx, src, axis=0):
    return tgt.clone().index_add_(axis, idx, src)
def _segment_sum(src, seg, n):
    out = torch.zeros((n,) + src.shape[1:], dtype=src.dtype)
    return out.index_add_(0, seg, src)
def _pad(x, pw):
    flat = tuple(v for pair in reversed(pw) for v in pair)
    return torch.nn.functional.pad(x, flat)

kernel_name = 'standalone__kv_cache_quant_int4_int2_kv_with_per_channel_or_per_token_scales__decode'

def setup_inputs():

    _w = (lambda a: (lambda t: t.to(torch.bfloat16) if t.is_floating_point() else t)(torch.as_tensor(a)))
    B = 2
    Sq = 1
    Skv = 32768
    Hq = 32
    Hkv = 8
    Dh = 128
    bits = 8
    G = 128
    if G <= 0 or G >= Skv:
        G = max(1, Skv // 2)
    Skv = (Skv // G) * G
    ngk = Skv // G
    qmax = (1 << bits) - 1
    return {
        "q": _w((lambda *s: torch.randn(*s, dtype=torch.bfloat16) * 0.4)(B, Hq, Sq, Dh)),
        "qk": _w(torch.randint(0, qmax + 1, (B, Hkv, Skv, Dh)).to(torch.int32)),
        "qv": _w(torch.randint(0, qmax + 1, (B, Hkv, Skv, Dh)).to(torch.int32)),
        "k_scales": _w(torch.abs((lambda *s: torch.randn(*s, dtype=torch.bfloat16) * 0.4)(B, Hkv, ngk, Dh)) * 0.05 + 0.02),
        "k_zeros": _w((lambda *s: torch.randn(*s, dtype=torch.bfloat16) * 0.4)(B, Hkv, ngk, Dh) + float(qmax) / 2.0),
        "v_scales": _w(torch.abs((lambda *s: torch.randn(*s, dtype=torch.bfloat16) * 0.05)(B, Hkv, Skv, 1)) * 0.05 + 0.02),
        "v_zeros": _w((lambda *s: torch.randn(*s, dtype=torch.bfloat16) * 0.05)(B, Hkv, Skv, 1) + float(qmax) / 2.0),
    }

def reference(q, qk, qv, k_scales, k_zeros, v_scales, v_zeros):
    B, Hq, Sq, Dh = q.shape
    Hkv, Skv = qk.shape[1], qk.shape[2]
    ngk = k_scales.shape[2]
    G = Skv // ngk
    ks = (lambda x, n, axis: torch.repeat_interleave(x, n, dim=axis))(k_scales, G, axis=2)
    kz = (lambda x, n, axis: torch.repeat_interleave(x, n, dim=axis))(k_zeros, G, axis=2)
    k = ((lambda x, dt: x.to(dt))(qk, q.dtype) - kz) * ks
    v = ((lambda x, dt: x.to(dt))(qv, q.dtype) - v_zeros) * v_scales
    rep = Hq // Hkv
    if rep > 1:
        k = (lambda x, n, axis: torch.repeat_interleave(x, n, dim=axis))(k, rep, axis=1)
        v = (lambda x, n, axis: torch.repeat_interleave(x, n, dim=axis))(v, rep, axis=1)
    scale = float(Dh) ** -0.5
    logits = torch.einsum("bhqd,bhkd->bhqk", q, k) * scale
    p = _softmax(logits, axis=-1)
    o = torch.einsum("bhqk,bhkd->bhqd", p, v)
    return o
```

```asm
; @launch grid=(256,1,1) block=(256,1,1) lds=62912
.amdgcn_target "amdgcn-amd-amdhsa--gfx950"
.text
.globl standalone__kv_cache_quant_int4_int2_kv_with_per_channel_or_per_token_scales__decode_kernel
.p2align 8
.type standalone__kv_cache_quant_int4_int2_kv_with_per_channel_or_per_token_scales__decode_kernel,@function
standalone__kv_cache_quant_int4_int2_kv_with_per_channel_or_per_token_scales__decode_kernel:
  s_cmp_ge_u32 s2, 256
  s_cbranch_scc1 L_end
  s_load_dwordx16 s[16:31], s[0:1], 0
  s_load_dwordx4 s[32:35], s[0:1], 64
  v_and_b32 v1, 63, v0
  v_lshrrev_b32 v95, 6, v0
  v_lshrrev_b32 v78, 4, v1
  v_readfirstlane_b32 s36, v95
  v_and_b32 v79, 3, v1
  v_bfe_u32 v80, v1, 2, 2
  v_and_b32 v81, 15, v1
  v_lshlrev_b32 v2, 4, v79
  v_lshl_add_u32 v2, v80, 9, v2
  v_lshl_add_u32 v2, v78, 6, v2
  v_lshlrev_b32 v3, 4, v81
  v_lshl_add_u32 v3, v78, 9, v3
  s_lshr_b32 s37, s2, 4
  s_and_b32 s48, s2, 7
  s_lshl_b32 s48, s48, 5
  s_lshl_b32 s38, s37, 8
  s_add_u32 s38, s38, s48
  s_bfe_u32 s48, s2, 0x10003
  s_add_u32 s38, s38, s48
  s_lshr_b32 s48, s2, 3
  s_add_u32 s39, s48, s2
  s_and_b32 s39, s39, 7
  s_lshl_b32 s48, s38, 16
  s_lshl_b32 s49, s36, 11
  s_add_u32 s48, s48, s49
  s_add_u32 s49, s39, 0
  s_and_b32 s49, s49, 7
  s_lshl_b32 s49, s49, 13
  s_add_u32 s60, s48, s49
  s_add_u32 s49, s39, 1
  s_and_b32 s49, s49, 7
  s_lshl_b32 s49, s49, 13
  s_add_u32 s61, s48, s49
  s_add_u32 s49, s39, 2
  s_and_b32 s49, s49, 7
  s_lshl_b32 s49, s49, 13
  s_add_u32 s62, s48, s49
  s_add_u32 s49, s39, 3
  s_and_b32 s49, s49, 7
  s_lshl_b32 s49, s49, 13
  s_add_u32 s63, s48, s49
  s_add_u32 s49, s39, 4
  s_and_b32 s49, s49, 7
  s_lshl_b32 s49, s49, 13
  s_add_u32 s64, s48, s49
  s_add_u32 s49, s39, 5
  s_and_b32 s49, s49, 7
  s_lshl_b32 s49, s49, 13
  s_add_u32 s65, s48, s49
  s_add_u32 s49, s39, 6
  s_and_b32 s49, s49, 7
  s_lshl_b32 s49, s49, 13
  s_add_u32 s66, s48, s49
  s_add_u32 s49, s39, 7
  s_and_b32 s49, s49, 7
  s_lshl_b32 s49, s49, 13
  s_add_u32 s67, s48, s49
  s_mov_b32 s41, 131072
  s_mov_b32 s47, 0xffe20000
  v_lshrrev_b32 v87, 4, v0
  v_and_b32 v88, 15, v0
  v_lshlrev_b32 v86, 9, v87
  v_lshl_add_u32 v86, v88, 4, v86
  s_lshl_b32 s48, s38, 8
  v_add_u32 v86, s48, v86
  v_lshlrev_b32 v89, 3, v79
  v_lshl_add_u32 v89, v78, 5, v89
  v_mov_b32 v4, v89
  v_lshl_add_u32 v89, v80, 8, v89
  s_lshl_b32 s48, s37, 10
  v_add_u32 v89, s48, v89
  s_waitcnt lgkmcnt(0)
  s_mov_b32 s8, s18
  s_mov_b32 s9, s19
  s_mov_b32 s10, 0x10000000
  s_mov_b32 s11, 0x20000
  s_mov_b32 s12, s20
  s_mov_b32 s13, s21
  s_mov_b32 s14, 0x10000000
  s_mov_b32 s15, 0x20000
  global_load_dwordx4 v[30:33], v86, s[22:23]
  global_load_dwordx4 v[34:37], v86, s[24:25]
  global_load_dwordx4 v[46:49], v86, s[26:27]
  global_load_dwordx4 v[54:57], v86, s[28:29]
  global_load_dwordx2 v[82:83], v89, s[16:17]
  global_load_dwordx2 v[84:85], v89, s[16:17] offset:128
  buffer_load_dwordx4 v[164:167], v2, s[8:11], s60 offen offset:0 nt
  buffer_load_dwordx4 v[168:171], v2, s[8:11], s60 offen offset:256 nt
  s_add_u32 s60, s60, s41
  buffer_load_dwordx4 v[172:175], v2, s[8:11], s61 offen offset:0 nt
  buffer_load_dwordx4 v[176:179], v2, s[8:11], s61 offen offset:256 nt
  s_add_u32 s61, s61, s41
  buffer_load_dwordx4 v[180:183], v2, s[8:11], s62 offen offset:0 nt
  s_mov_b32 s43, 0x3e0293ee
  s_mov_b32 s44, 0x07060302
  s_mov_b32 s45, 0xffff0000
  s_mov_b32 s46, 0x80008000
  v_mul_u32_u24 v90, 1280, v87
  v_lshl_add_u32 v91, v88, 4, v90
  v_lshrrev_b32 v92, 1, v88
  v_subrev_u32 v92, s39, v92
  v_and_b32 v92, 7, v92
  v_and_b32 v93, 1, v88
  v_mul_u32_u24 v93, 384, v93
  v_add_u32 v93, v93, v90
  v_lshl_add_u32 v90, v92, 2, v93
  v_lshl_add_u32 v93, v92, 1, v93
  s_lshl_b32 s48, s36, 2
  v_add_u32 v5, s48, v78
  v_mul_u32_u24 v5, 48, v5
  v_add_u32 v5, 512, v5
  v_lshrrev_b32 v9, 2, v1
  v_lshlrev_b32 v9, 5, v9
  s_lshl_b32 s48, s36, 13
  s_add_u32 s48, s48, 21760
  v_add_u32 v9, s48, v9
  v_cmp_eq_u32 vcc, 1, v79
  v_mov_b32 v8, 0
  v_mov_b32 v95, s45
  v_cndmask_b32 v8, v8, v95, vcc
  v_mov_b32 v6, 0xff7fffff
  v_mov_b32 v7, 0
  v_mov_b32 v128, 0
  v_mov_b32 v129, 0
  v_mov_b32 v130, 0
  v_mov_b32 v131, 0
  v_mov_b32 v132, 0
  v_mov_b32 v133, 0
  v_mov_b32 v134, 0
  v_mov_b32 v135, 0
  v_mov_b32 v136, 0
  v_mov_b32 v137, 0
  v_mov_b32 v138, 0
  v_mov_b32 v139, 0
  v_mov_b32 v140, 0
  v_mov_b32 v141, 0
  v_mov_b32 v142, 0
  v_mov_b32 v143, 0
  v_mov_b32 v144, 0
  v_mov_b32 v145, 0
  v_mov_b32 v146, 0
  v_mov_b32 v147, 0
  v_mov_b32 v148, 0
  v_mov_b32 v149, 0
  v_mov_b32 v150, 0
  v_mov_b32 v151, 0
  v_mov_b32 v152, 0
  v_mov_b32 v153, 0
  v_mov_b32 v154, 0
  v_mov_b32 v155, 0
  v_mov_b32 v156, 0
  v_mov_b32 v157, 0
  v_mov_b32 v158, 0
  v_mov_b32 v159, 0
  v_mov_b32 v160, 0
  v_mov_b32 v161, 0
  v_mov_b32 v162, 0
  v_mov_b32 v163, 0
  s_waitcnt vmcnt(5)
  ds_write_b128 v91, v[30:33]
  ds_write_b128 v91, v[34:37] offset:256
  ds_write_b16 v93, v54 offset:544
  ds_write_b16_d16_hi v93, v54 offset:592
  ds_write_b16 v93, v55 offset:640
  ds_write_b16_d16_hi v93, v55 offset:688
  ds_write_b16 v93, v56 offset:736
  ds_write_b16_d16_hi v93, v56 offset:784
  ds_write_b16 v93, v57 offset:832
  ds_write_b16_d16_hi v93, v57 offset:880
  v_lshlrev_b32 v38, 16, v46
  v_and_b32 v39, s45, v46
  v_lshlrev_b32 v40, 16, v47
  v_and_b32 v41, s45, v47
  v_lshlrev_b32 v42, 16, v48
  v_and_b32 v43, s45, v48
  v_lshlrev_b32 v44, 16, v49
  v_and_b32 v45, s45, v49
  ds_write_b32 v90, v38 offset:512
  ds_write_b32 v90, v39 offset:560
  ds_write_b32 v90, v40 offset:608
  ds_write_b32 v90, v41 offset:656
  ds_write_b32 v90, v42 offset:704
  ds_write_b32 v90, v43 offset:752
  ds_write_b32 v90, v44 offset:800
  ds_write_b32 v90, v45 offset:848
  v_lshlrev_b32 v10, 16, v82
  v_and_b32 v11, s45, v82
  v_lshlrev_b32 v12, 16, v83
  v_and_b32 v13, s45, v83
  v_lshlrev_b32 v14, 16, v84
  v_and_b32 v15, s45, v84
  v_lshlrev_b32 v16, 16, v85
  v_and_b32 v17, s45, v85
  s_waitcnt lgkmcnt(0)
  s_barrier
  ds_read2_b64 v[30:33], v4 offset0:0 offset1:16
  ds_read2_b64 v[34:37], v4 offset0:32 offset1:48
  v_add_u32 v4, 1280, v4
  s_waitcnt lgkmcnt(0)
  v_lshlrev_b32 v78, 16, v30
  v_and_b32 v79, s45, v30
  v_lshlrev_b32 v80, 16, v31
  v_and_b32 v81, s45, v31
  v_lshlrev_b32 v82, 16, v32
  v_and_b32 v83, s45, v32
  v_lshlrev_b32 v84, 16, v33
  v_and_b32 v85, s45, v33
  v_mul_f32 v78, v10, v78
  v_mul_f32 v79, v11, v79
  v_mul_f32 v80, v12, v80
  v_mul_f32 v81, v13, v81
  v_mul_f32 v82, v14, v82
  v_mul_f32 v83, v15, v83
  v_mul_f32 v84, v16, v84
  v_mul_f32 v85, v17, v85
  v_perm_b32 v18, v79, v78, s44
  v_perm_b32 v19, v81, v80, s44
  v_perm_b32 v20, v83, v82, s44
  v_perm_b32 v21, v85, v84, s44
  v_and_b32 v86, s45, v78
  v_and_b32 v87, s45, v79
  v_and_b32 v88, s45, v80
  v_and_b32 v89, s45, v81
  v_and_b32 v90, s45, v82
  v_and_b32 v91, s45, v83
  v_and_b32 v92, s45, v84
  v_and_b32 v93, s45, v85
  v_sub_f32 v78, v78, v86
  v_sub_f32 v79, v79, v87
  v_sub_f32 v80, v80, v88
  v_sub_f32 v81, v81, v89
  v_sub_f32 v82, v82, v90
  v_sub_f32 v83, v83, v91
  v_sub_f32 v84, v84, v92
  v_sub_f32 v85, v85, v93
  v_perm_b32 v22, v79, v78, s44
  v_perm_b32 v23, v81, v80, s44
  v_perm_b32 v24, v83, v82, s44
  v_perm_b32 v25, v85, v84, s44
  v_xor_b32 v34, s46, v34
  v_xor_b32 v35, s46, v35
  v_xor_b32 v36, s46, v36
  v_xor_b32 v37, s46, v37
  s_nop 1
  v_mfma_f32_16x16x32_bf16 v[26:29], v[34:37], v[18:21], 0
  v_mfma_f32_16x16x32_bf16 v[26:29], v[34:37], v[22:25], v[26:29]
  s_mov_b32 s40, 15
  s_mov_b32 s97, 1
L_kA:
  s_cmp_eq_u32 s40, 1
  s_cselect_b32 s42, s47, s41
  ds_read2_b64 v[30:33], v4 offset0:0 offset1:16
  ds_read2_b64 v[34:37], v4 offset0:32 offset1:48
  v_add_u32 v4, 1280, v4
  s_waitcnt vmcnt(4)
  buffer_load_dwordx4 v[184:187], v2, s[8:11], s62 offen offset:256 nt
  s_add_u32 s62, s62, s41
  v_cvt_f32_i32 v164, v164
  v_cvt_f32_i32 v165, v165
  v_cvt_f32_i32 v166, v166
  v_cvt_f32_i32 v167, v167
  v_cvt_pk_bf16_f32 v62, v164, v165
  v_cvt_pk_bf16_f32 v63, v166, v167
  s_waitcnt vmcnt(4)
  buffer_load_dwordx4 v[188:191], v2, s[8:11], s63 offen offset:0 nt
  v_cvt_f32_i32 v168, v168
  v_cvt_f32_i32 v169, v169
  v_cvt_f32_i32 v170, v170
  v_cvt_f32_i32 v171, v171
  v_cvt_pk_bf16_f32 v64, v168, v169
  v_cvt_pk_bf16_f32 v65, v170, v171
  s_nop 1
  v_mfma_f32_16x16x32_bf16 v[70:73], v[62:65], v[18:21], v[26:29]
  v_mfma_f32_16x16x32_bf16 v[70:73], v[62:65], v[22:25], v[70:73]
  s_waitcnt vmcnt(4)
  buffer_load_dwordx4 v[192:195], v2, s[8:11], s63 offen offset:256 nt
  s_add_u32 s63, s63, s41
  v_cvt_f32_i32 v172, v172
  v_cvt_f32_i32 v173, v173
  v_cvt_f32_i32 v174, v174
  v_cvt_f32_i32 v175, v175
  v_cvt_pk_bf16_f32 v66, v172, v173
  v_cvt_pk_bf16_f32 v67, v174, v175
  s_waitcnt lgkmcnt(0)
  v_lshlrev_b32 v78, 16, v30
  v_and_b32 v79, s45, v30
  v_lshlrev_b32 v80, 16, v31
  v_and_b32 v81, s45, v31
  v_lshlrev_b32 v82, 16, v32
  v_and_b32 v83, s45, v32
  v_lshlrev_b32 v84, 16, v33
  v_and_b32 v85, s45, v33
  s_waitcnt vmcnt(4)
  buffer_load_dwordx4 v[196:199], v2, s[8:11], s64 offen offset:0 nt
  v_cvt_f32_i32 v176, v176
  v_cvt_f32_i32 v177, v177
  v_cvt_f32_i32 v178, v178
  v_cvt_f32_i32 v179, v179
  v_mov_b32_dpp v38, v70 quad_perm:[0,0,0,0] row_mask:0xf bank_mask:0xf
  v_cvt_pk_bf16_f32 v68, v176, v177
  v_cvt_pk_bf16_f32 v69, v178, v179
  v_add_f32_dpp v38, v71, v38 quad_perm:[1,1,1,1] row_mask:0xf bank_mask:0xf
  s_nop 0
  v_mfma_f32_16x16x32_bf16 v[74:77], v[66:69], v[18:21], v[26:29]
  v_add_f32_dpp v38, v72, v38 quad_perm:[2,2,2,2] row_mask:0xf bank_mask:0xf
  v_mfma_f32_16x16x32_bf16 v[74:77], v[66:69], v[22:25], v[74:77]
  s_nop 0
  v_add_f32_dpp v38, v73, v38 quad_perm:[3,3,3,3] row_mask:0xf bank_mask:0xf
  v_mul_f32 v38, s43, v38
  s_waitcnt vmcnt(4)
  buffer_load_dwordx4 v[200:203], v2, s[8:11], s64 offen offset:256 nt
  s_add_u32 s64, s64, s41
  v_cvt_f32_i32 v180, v180
  v_cvt_f32_i32 v181, v181
  v_cvt_f32_i32 v182, v182
  v_cvt_f32_i32 v183, v183
  v_cvt_pk_bf16_f32 v62, v180, v181
  v_cvt_pk_bf16_f32 v63, v182, v183
  v_mul_f32 v78, v10, v78
  v_mul_f32 v79, v11, v79
  v_mul_f32 v80, v12, v80
  v_mul_f32 v81, v13, v81
  v_mul_f32 v82, v14, v82
  v_mul_f32 v83, v15, v83
  v_mul_f32 v84, v16, v84
  v_mul_f32 v85, v17, v85
  s_waitcnt vmcnt(4)
  buffer_load_dwordx4 v[204:207], v2, s[8:11], s65 offen offset:0 nt
  v_cvt_f32_i32 v184, v184
  v_cvt_f32_i32 v185, v185
  v_cvt_f32_i32 v186, v186
  v_cvt_f32_i32 v187, v187
  v_mov_b32_dpp v39, v74 quad_perm:[0,0,0,0] row_mask:0xf bank_mask:0xf
  v_cvt_pk_bf16_f32 v64, v184, v185
  v_cvt_pk_bf16_f32 v65, v186, v187
  v_add_f32_dpp v39, v75, v39 quad_perm:[1,1,1,1] row_mask:0xf bank_mask:0xf
  s_nop 0
  v_mfma_f32_16x16x32_bf16 v[70:73], v[62:65], v[18:21], v[26:29]
  v_add_f32_dpp v39, v76, v39 quad_perm:[2,2,2,2] row_mask:0xf bank_mask:0xf
  v_mfma_f32_16x16x32_bf16 v[70:73], v[62:65], v[22:25], v[70:73]
  s_nop 0
  v_add_f32_dpp v39, v77, v39 quad_perm:[3,3,3,3] row_mask:0xf bank_mask:0xf
  v_mul_f32 v39, s43, v39
  s_waitcnt vmcnt(4)
  buffer_load_dwordx4 v[208:211], v2, s[8:11], s65 offen offset:256 nt
  s_add_u32 s65, s65, s41
  v_cvt_f32_i32 v188, v188
  v_cvt_f32_i32 v189, v189
  v_cvt_f32_i32 v190, v190
  v_cvt_f32_i32 v191, v191
  v_cvt_pk_bf16_f32 v66, v188, v189
  v_cvt_pk_bf16_f32 v67, v190, v191
  v_perm_b32 v96, v79, v78, s44
  v_perm_b32 v97, v81, v80, s44
  v_perm_b32 v98, v83, v82, s44
  v_perm_b32 v99, v85, v84, s44
  v_and_b32 v86, s45, v78
  v_and_b32 v87, s45, v79
  v_and_b32 v88, s45, v80
  v_and_b32 v89, s45, v81
  s_waitcnt vmcnt(4)
  buffer_load_dwordx4 v[212:215], v2, s[8:11], s66 offen offset:0 nt
  v_cvt_f32_i32 v192, v192
  v_cvt_f32_i32 v193, v193
  v_cvt_f32_i32 v194, v194
  v_cvt_f32_i32 v195, v195
  v_mov_b32_dpp v40, v70 quad_perm:[0,0,0,0] row_mask:0xf bank_mask:0xf
  v_cvt_pk_bf16_f32 v68, v192, v193
  v_cvt_pk_bf16_f32 v69, v194, v195
  v_add_f32_dpp v40, v71, v40 quad_perm:[1,1,1,1] row_mask:0xf bank_mask:0xf
  s_nop 0
  v_mfma_f32_16x16x32_bf16 v[74:77], v[66:69], v[18:21], v[26:29]
  v_add_f32_dpp v40, v72, v40 quad_perm:[2,2,2,2] row_mask:0xf bank_mask:0xf
  v_mfma_f32_16x16x32_bf16 v[74:77], v[66:69], v[22:25], v[74:77]
  s_nop 0
  v_add_f32_dpp v40, v73, v40 quad_perm:[3,3,3,3] row_mask:0xf bank_mask:0xf
  v_mul_f32 v40, s43, v40
  s_waitcnt vmcnt(4)
  buffer_load_dwordx4 v[216:219], v2, s[8:11], s66 offen offset:256 nt
  s_add_u32 s66, s66, s41
  v_cvt_f32_i32 v196, v196
  v_cvt_f32_i32 v197, v197
  v_cvt_f32_i32 v198, v198
  v_cvt_f32_i32 v199, v199
  v_cvt_pk_bf16_f32 v62, v196, v197
  v_cvt_pk_bf16_f32 v63, v198, v199
  v_and_b32 v90, s45, v82
  v_and_b32 v91, s45, v83
  v_and_b32 v92, s45, v84
  v_and_b32 v93, s45, v85
  v_sub_f32 v78, v78, v86
  v_sub_f32 v79, v79, v87
  v_sub_f32 v80, v80, v88
  v_sub_f32 v81, v81, v89
  s_waitcnt vmcnt(4)
  buffer_load_dwordx4 v[220:223], v2, s[8:11], s67 offen offset:0 nt
  v_cvt_f32_i32 v200, v200
  v_cvt_f32_i32 v201, v201
  v_cvt_f32_i32 v202, v202
  v_cvt_f32_i32 v203, v203
  v_mov_b32_dpp v41, v74 quad_perm:[0,0,0,0] row_mask:0xf bank_mask:0xf
  v_cvt_pk_bf16_f32 v64, v200, v201
  v_cvt_pk_bf16_f32 v65, v202, v203
  v_add_f32_dpp v41, v75, v41 quad_perm:[1,1,1,1] row_mask:0xf bank_mask:0xf
  s_nop 0
  v_mfma_f32_16x16x32_bf16 v[70:73], v[62:65], v[18:21], v[26:29]
  v_add_f32_dpp v41, v76, v41 quad_perm:[2,2,2,2] row_mask:0xf bank_mask:0xf
  v_mfma_f32_16x16x32_bf16 v[70:73], v[62:65], v[22:25], v[70:73]
  s_nop 0
  v_add_f32_dpp v41, v77, v41 quad_perm:[3,3,3,3] row_mask:0xf bank_mask:0xf
  v_mul_f32 v41, s43, v41
  s_waitcnt vmcnt(4)
  buffer_load_dwordx4 v[224:227], v2, s[8:11], s67 offen offset:256 nt
  s_add_u32 s67, s67, s41
  v_cvt_f32_i32 v204, v204
  v_cvt_f32_i32 v205, v205
  v_cvt_f32_i32 v206, v206
  v_cvt_f32_i32 v207, v207
  v_cvt_pk_bf16_f32 v66, v204, v205
  v_cvt_pk_bf16_f32 v67, v206, v207
  v_sub_f32 v82, v82, v90
  v_sub_f32 v83, v83, v91
  v_sub_f32 v84, v84, v92
  v_sub_f32 v85, v85, v93
  v_perm_b32 v100, v79, v78, s44
  v_perm_b32 v101, v81, v80, s44
  v_perm_b32 v102, v83, v82, s44
  v_perm_b32 v103, v85, v84, s44
  s_waitcnt vmcnt(4)
  buffer_load_dwordx4 v[164:167], v2, s[8:11], s60 offen offset:0 nt
  v_cvt_f32_i32 v208, v208
  v_cvt_f32_i32 v209, v209
  v_cvt_f32_i32 v210, v210
  v_cvt_f32_i32 v211, v211
  v_mov_b32_dpp v42, v70 quad_perm:[0,0,0,0] row_mask:0xf bank_mask:0xf
  v_cvt_pk_bf16_f32 v68, v208, v209
  v_cvt_pk_bf16_f32 v69, v210, v211
  v_add_f32_dpp v42, v71, v42 quad_perm:[1,1,1,1] row_mask:0xf bank_mask:0xf
  s_nop 0
  v_mfma_f32_16x16x32_bf16 v[74:77], v[66:69], v[18:21], v[26:29]
  v_add_f32_dpp v42, v72, v42 quad_perm:[2,2,2,2] row_mask:0xf bank_mask:0xf
  v_mfma_f32_16x16x32_bf16 v[74:77], v[66:69], v[22:25], v[74:77]
  s_nop 0
  v_add_f32_dpp v42, v73, v42 quad_perm:[3,3,3,3] row_mask:0xf bank_mask:0xf
  v_mul_f32 v42, s43, v42
  s_waitcnt vmcnt(4)
  buffer_load_dwordx4 v[168:171], v2, s[8:11], s60 offen offset:256 nt
  s_add_u32 s60, s60, s42
  s_memrealtime s[94:95]
  v_cvt_f32_i32 v212, v212
  v_cvt_f32_i32 v213, v213
  v_cvt_f32_i32 v214, v214
  v_cvt_f32_i32 v215, v215
  v_cvt_pk_bf16_f32 v62, v212, v213
  v_cvt_pk_bf16_f32 v63, v214, v215
  v_xor_b32 v34, s46, v34
  v_xor_b32 v35, s46, v35
  v_xor_b32 v36, s46, v36
  v_xor_b32 v37, s46, v37
  s_nop 1
  v_mfma_f32_16x16x32_bf16 v[104:107], v[34:37], v[96:99], 0
  v_mfma_f32_16x16x32_bf16 v[104:107], v[34:37], v[100:103], v[104:107]
  s_waitcnt vmcnt(4)
  buffer_load_dwordx4 v[172:175], v2, s[8:11], s61 offen offset:0 nt
  v_cvt_f32_i32 v216, v216
  v_cvt_f32_i32 v217, v217
  v_cvt_f32_i32 v218, v218
  v_cvt_f32_i32 v219, v219
  v_mov_b32_dpp v43, v74 quad_perm:[0,0,0,0] row_mask:0xf bank_mask:0xf
  v_cvt_pk_bf16_f32 v64, v216, v217
  v_cvt_pk_bf16_f32 v65, v218, v219
  v_add_f32_dpp v43, v75, v43 quad_perm:[1,1,1,1] row_mask:0xf bank_mask:0xf
  s_nop 0
  v_mfma_f32_16x16x32_bf16 v[70:73], v[62:65], v[18:21], v[26:29]
  v_add_f32_dpp v43, v76, v43 quad_perm:[2,2,2,2] row_mask:0xf bank_mask:0xf
  v_mfma_f32_16x16x32_bf16 v[70:73], v[62:65], v[22:25], v[70:73]
  s_nop 0
  v_add_f32_dpp v43, v77, v43 quad_perm:[3,3,3,3] row_mask:0xf bank_mask:0xf
  v_mul_f32 v43, s43, v43
  s_waitcnt vmcnt(4)
  buffer_load_dwordx4 v[176:179], v2, s[8:11], s61 offen offset:256 nt
  s_add_u32 s61, s61, s42
  v_cvt_f32_i32 v220, v220
  v_cvt_f32_i32 v221, v221
  v_cvt_f32_i32 v222, v222
  v_cvt_f32_i32 v223, v223
  v_cvt_pk_bf16_f32 v66, v220, v221
  v_cvt_pk_bf16_f32 v67, v222, v223
  s_waitcnt vmcnt(4)
  buffer_load_dwordx4 v[180:183], v2, s[8:11], s62 offen offset:0 nt
  v_cvt_f32_i32 v224, v224
  v_cvt_f32_i32 v225, v225
  v_cvt_f32_i32 v226, v226
  v_cvt_f32_i32 v227, v227
  v_mov_b32_dpp v44, v70 quad_perm:[0,0,0,0] row_mask:0xf bank_mask:0xf
  v_cvt_pk_bf16_f32 v68, v224, v225
  v_cvt_pk_bf16_f32 v69, v226, v227
  v_add_f32_dpp v44, v71, v44 quad_perm:[1,1,1,1] row_mask:0xf bank_mask:0xf
  s_nop 0
  v_mfma_f32_16x16x32_bf16 v[74:77], v[66:69], v[18:21], v[26:29]
  v_add_f32_dpp v44, v72, v44 quad_perm:[2,2,2,2] row_mask:0xf bank_mask:0xf
  v_mfma_f32_16x16x32_bf16 v[74:77], v[66:69], v[22:25], v[74:77]
  s_nop 0
  v_add_f32_dpp v44, v73, v44 quad_perm:[3,3,3,3] row_mask:0xf bank_mask:0xf
  v_mul_f32 v44, s43, v44
  v_mov_b32 v18, v96
  v_mov_b32 v19, v97
  v_mov_b32 v20, v98
  v_mov_b32 v21, v99
  v_mov_b32 v22, v100
  v_mov_b32 v23, v101
  v_mov_b32 v24, v102
  v_mov_b32 v25, v103
  v_mov_b32 v26, v104
  v_mov_b32 v27, v105
  v_mov_b32 v28, v106
  v_mov_b32 v29, v107
  s_waitcnt lgkmcnt(0)
  v_mov_b32_dpp v45, v74 quad_perm:[0,0,0,0] row_mask:0xf bank_mask:0xf
  v_max3_f32 v6, v6, v38, v39
  v_max3_f32 v6, v6, v40, v41
  v_add_f32_dpp v45, v75, v45 quad_perm:[1,1,1,1] row_mask:0xf bank_mask:0xf
  v_max3_f32 v6, v6, v42, v43
  s_nop 0
  v_add_f32_dpp v45, v76, v45 quad_perm:[2,2,2,2] row_mask:0xf bank_mask:0xf
  ds_write_b128 v9, v[38:41]
  s_nop 0
  v_add_f32_dpp v45, v77, v45 quad_perm:[3,3,3,3] row_mask:0xf bank_mask:0xf
  v_mul_f32 v45, s43, v45
  v_max3_f32 v6, v6, v44, v45
  ds_write_b128 v9, v[42:45] offset:16
  v_add_u32 v9, 512, v9
  s_cmp_eq_u32 s97, 1
  s_cselect_b32 s96, s94, s96
  s_mov_b32 s97, 0
  s_sub_u32 s98, s94, s96
  s_add_u32 s96, s96, 216
  s_sub_u32 s40, s40, 1
  s_cmp_eq_u32 s40, 0
  s_cbranch_scc1 L_klast
  s_cmp_gt_i32 s98, 0
  s_cbranch_scc0 L_kA
L_kB:
  s_cmp_eq_u32 s40, 1
  s_cselect_b32 s42, s47, s41
  ds_read2_b64 v[30:33], v4 offset0:0 offset1:16
  ds_read2_b64 v[34:37], v4 offset0:32 offset1:48
  v_add_u32 v4, 1280, v4
  s_waitcnt vmcnt(4)
  buffer_load_dwordx4 v[184:187], v2, s[8:11], s62 offen offset:256 nt
  s_add_u32 s62, s62, s41
  buffer_load_dwordx4 v[188:191], v2, s[8:11], s63 offen offset:0 nt
  v_cvt_f32_i32 v164, v164
  v_cvt_f32_i32 v165, v165
  v_cvt_f32_i32 v166, v166
  v_cvt_f32_i32 v167, v167
  v_cvt_pk_bf16_f32 v62, v164, v165
  v_cvt_pk_bf16_f32 v63, v166, v167
  s_waitcnt vmcnt(5)
  buffer_load_dwordx4 v[192:195], v2, s[8:11], s63 offen offset:256 nt
  s_add_u32 s63, s63, s41
  v_cvt_f32_i32 v168, v168
  v_cvt_f32_i32 v169, v169
  v_cvt_f32_i32 v170, v170
  v_cvt_f32_i32 v171, v171
  v_cvt_pk_bf16_f32 v64, v168, v169
  v_cvt_pk_bf16_f32 v65, v170, v171
  s_nop 1
  v_mfma_f32_16x16x32_bf16 v[70:73], v[62:65], v[18:21], v[26:29]
  v_mfma_f32_16x16x32_bf16 v[70:73], v[62:65], v[22:25], v[70:73]
  s_waitcnt vmcnt(5)
  buffer_load_dwordx4 v[196:199], v2, s[8:11], s64 offen offset:0 nt
  v_cvt_f32_i32 v172, v172
  v_cvt_f32_i32 v173, v173
  v_cvt_f32_i32 v174, v174
  v_cvt_f32_i32 v175, v175
  v_cvt_pk_bf16_f32 v66, v172, v173
  v_cvt_pk_bf16_f32 v67, v174, v175
  s_waitcnt lgkmcnt(0)
  v_lshlrev_b32 v78, 16, v30
  v_and_b32 v79, s45, v30
  v_lshlrev_b32 v80, 16, v31
  v_and_b32 v81, s45, v31
  v_lshlrev_b32 v82, 16, v32
  v_and_b32 v83, s45, v32
  v_lshlrev_b32 v84, 16, v33
  v_and_b32 v85, s45, v33
  s_waitcnt vmcnt(5)
  buffer_load_dwordx4 v[200:203], v2, s[8:11], s64 offen offset:256 nt
  s_add_u32 s64, s64, s41
  v_cvt_f32_i32 v176, v176
  v_cvt_f32_i32 v177, v177
  v_cvt_f32_i32 v178, v178
  v_cvt_f32_i32 v179, v179
  v_mov_b32_dpp v38, v70 quad_perm:[0,0,0,0] row_mask:0xf bank_mask:0xf
  v_cvt_pk_bf16_f32 v68, v176, v177
  v_cvt_pk_bf16_f32 v69, v178, v179
  v_add_f32_dpp v38, v71, v38 quad_perm:[1,1,1,1] row_mask:0xf bank_mask:0xf
  s_nop 0
  v_mfma_f32_16x16x32_bf16 v[74:77], v[66:69], v[18:21], v[26:29]
  v_add_f32_dpp v38, v72, v38 quad_perm:[2,2,2,2] row_mask:0xf bank_mask:0xf
  v_mfma_f32_16x16x32_bf16 v[74:77], v[66:69], v[22:25], v[74:77]
  s_nop 0
  v_add_f32_dpp v38, v73, v38 quad_perm:[3,3,3,3] row_mask:0xf bank_mask:0xf
  v_mul_f32 v38, s43, v38
  s_waitcnt vmcnt(5)
  buffer_load_dwordx4 v[204:207], v2, s[8:11], s65 offen offset:0 nt
  v_cvt_f32_i32 v180, v180
  v_cvt_f32_i32 v181, v181
  v_cvt_f32_i32 v182, v182
  v_cvt_f32_i32 v183, v183
  v_cvt_pk_bf16_f32 v62, v180, v181
  v_cvt_pk_bf16_f32 v63, v182, v183
  v_mul_f32 v78, v10, v78
  v_mul_f32 v79, v11, v79
  v_mul_f32 v80, v12, v80
  v_mul_f32 v81, v13, v81
  v_mul_f32 v82, v14, v82
  v_mul_f32 v83, v15, v83
  v_mul_f32 v84, v16, v84
  v_mul_f32 v85, v17, v85
  s_waitcnt vmcnt(5)
  buffer_load_dwordx4 v[208:211], v2, s[8:11], s65 offen offset:256 nt
  s_add_u32 s65, s65, s41
  v_cvt_f32_i32 v184, v184
  v_cvt_f32_i32 v185, v185
  v_cvt_f32_i32 v186, v186
  v_cvt_f32_i32 v187, v187
  v_mov_b32_dpp v39, v74 quad_perm:[0,0,0,0] row_mask:0xf bank_mask:0xf
  v_cvt_pk_bf16_f32 v64, v184, v185
  v_cvt_pk_bf16_f32 v65, v186, v187
  v_add_f32_dpp v39, v75, v39 quad_perm:[1,1,1,1] row_mask:0xf bank_mask:0xf
  s_nop 0
  v_mfma_f32_16x16x32_bf16 v[70:73], v[62:65], v[18:21], v[26:29]
  v_add_f32_dpp v39, v76, v39 quad_perm:[2,2,2,2] row_mask:0xf bank_mask:0xf
  v_mfma_f32_16x16x32_bf16 v[70:73], v[62:65], v[22:25], v[70:73]
  s_nop 0
  v_add_f32_dpp v39, v77, v39 quad_perm:[3,3,3,3] row_mask:0xf bank_mask:0xf
  v_mul_f32 v39, s43, v39
  s_waitcnt vmcnt(5)
  buffer_load_dwordx4 v[212:215], v2, s[8:11], s66 offen offset:0 nt
  v_cvt_f32_i32 v188, v188
  v_cvt_f32_i32 v189, v189
  v_cvt_f32_i32 v190, v190
  v_cvt_f32_i32 v191, v191
  v_cvt_pk_bf16_f32 v66, v188, v189
  v_cvt_pk_bf16_f32 v67, v190, v191
  v_perm_b32 v96, v79, v78, s44
  v_perm_b32 v97, v81, v80, s44
  v_perm_b32 v98, v83, v82, s44
  v_perm_b32 v99, v85, v84, s44
  v_and_b32 v86, s45, v78
  v_and_b32 v87, s45, v79
  v_and_b32 v88, s45, v80
  v_and_b32 v89, s45, v81
  s_waitcnt vmcnt(5)
  buffer_load_dwordx4 v[216:219], v2, s[8:11], s66 offen offset:256 nt
  s_add_u32 s66, s66, s41
  v_cvt_f32_i32 v192, v192
  v_cvt_f32_i32 v193, v193
  v_cvt_f32_i32 v194, v194
  v_cvt_f32_i32 v195, v195
  v_mov_b32_dpp v40, v70 quad_perm:[0,0,0,0] row_mask:0xf bank_mask:0xf
  v_cvt_pk_bf16_f32 v68, v192, v193
  v_cvt_pk_bf16_f32 v69, v194, v195
  v_add_f32_dpp v40, v71, v40 quad_perm:[1,1,1,1] row_mask:0xf bank_mask:0xf
  s_nop 0
  v_mfma_f32_16x16x32_bf16 v[74:77], v[66:69], v[18:21], v[26:29]
  v_add_f32_dpp v40, v72, v40 quad_perm:[2,2,2,2] row_mask:0xf bank_mask:0xf
  v_mfma_f32_16x16x32_bf16 v[74:77], v[66:69], v[22:25], v[74:77]
  s_nop 0
  v_add_f32_dpp v40, v73, v40 quad_perm:[3,3,3,3] row_mask:0xf bank_mask:0xf
  v_mul_f32 v40, s43, v40
  s_waitcnt vmcnt(5)
  buffer_load_dwordx4 v[220:223], v2, s[8:11], s67 offen offset:0 nt
  v_cvt_f32_i32 v196, v196
  v_cvt_f32_i32 v197, v197
  v_cvt_f32_i32 v198, v198
  v_cvt_f32_i32 v199, v199
  v_cvt_pk_bf16_f32 v62, v196, v197
  v_cvt_pk_bf16_f32 v63, v198, v199
  v_and_b32 v90, s45, v82
  v_and_b32 v91, s45, v83
  v_and_b32 v92, s45, v84
  v_and_b32 v93, s45, v85
  v_sub_f32 v78, v78, v86
  v_sub_f32 v79, v79, v87
  v_sub_f32 v80, v80, v88
  v_sub_f32 v81, v81, v89
  s_waitcnt vmcnt(5)
  buffer_load_dwordx4 v[224:227], v2, s[8:11], s67 offen offset:256 nt
  s_add_u32 s67, s67, s41
  v_cvt_f32_i32 v200, v200
  v_cvt_f32_i32 v201, v201
  v_cvt_f32_i32 v202, v202
  v_cvt_f32_i32 v203, v203
  v_mov_b32_dpp v41, v74 quad_perm:[0,0,0,0] row_mask:0xf bank_mask:0xf
  v_cvt_pk_bf16_f32 v64, v200, v201
  v_cvt_pk_bf16_f32 v65, v202, v203
  v_add_f32_dpp v41, v75, v41 quad_perm:[1,1,1,1] row_mask:0xf bank_mask:0xf
  s_nop 0
  v_mfma_f32_16x16x32_bf16 v[70:73], v[62:65], v[18:21], v[26:29]
  v_add_f32_dpp v41, v76, v41 quad_perm:[2,2,2,2] row_mask:0xf bank_mask:0xf
  v_mfma_f32_16x16x32_bf16 v[70:73], v[62:65], v[22:25], v[70:73]
  s_nop 0
  v_add_f32_dpp v41, v77, v41 quad_perm:[3,3,3,3] row_mask:0xf bank_mask:0xf
  v_mul_f32 v41, s43, v41
  s_waitcnt vmcnt(5)
  buffer_load_dwordx4 v[164:167], v2, s[8:11], s60 offen offset:0 nt
  v_cvt_f32_i32 v204, v204
  v_cvt_f32_i32 v205, v205
  v_cvt_f32_i32 v206, v206
  v_cvt_f32_i32 v207, v207
  v_cvt_pk_bf16_f32 v66, v204, v205
  v_cvt_pk_bf16_f32 v67, v206, v207
  v_sub_f32 v82, v82, v90
  v_sub_f32 v83, v83, v91
  v_sub_f32 v84, v84, v92
  v_sub_f32 v85, v85, v93
  v_perm_b32 v100, v79, v78, s44
  v_perm_b32 v101, v81, v80, s44
  v_perm_b32 v102, v83, v82, s44
  v_perm_b32 v103, v85, v84, s44
  s_waitcnt vmcnt(5)
  buffer_load_dwordx4 v[168:171], v2, s[8:11], s60 offen offset:256 nt
  s_add_u32 s60, s60, s42
  v_cvt_f32_i32 v208, v208
  v_cvt_f32_i32 v209, v209
  v_cvt_f32_i32 v210, v210
  v_cvt_f32_i32 v211, v211
  v_mov_b32_dpp v42, v70 quad_perm:[0,0,0,0] row_mask:0xf bank_mask:0xf
  v_cvt_pk_bf16_f32 v68, v208, v209
  v_cvt_pk_bf16_f32 v69, v210, v211
  v_add_f32_dpp v42, v71, v42 quad_perm:[1,1,1,1] row_mask:0xf bank_mask:0xf
  s_nop 0
  v_mfma_f32_16x16x32_bf16 v[74:77], v[66:69], v[18:21], v[26:29]
  v_add_f32_dpp v42, v72, v42 quad_perm:[2,2,2,2] row_mask:0xf bank_mask:0xf
  v_mfma_f32_16x16x32_bf16 v[74:77], v[66:69], v[22:25], v[74:77]
  s_nop 0
  v_add_f32_dpp v42, v73, v42 quad_perm:[3,3,3,3] row_mask:0xf bank_mask:0xf
  v_mul_f32 v42, s43, v42
  s_waitcnt vmcnt(5)
  buffer_load_dwordx4 v[172:175], v2, s[8:11], s61 offen offset:0 nt
  s_memrealtime s[94:95]
  v_cvt_f32_i32 v212, v212
  v_cvt_f32_i32 v213, v213
  v_cvt_f32_i32 v214, v214
  v_cvt_f32_i32 v215, v215
  v_cvt_pk_bf16_f32 v62, v212, v213
  v_cvt_pk_bf16_f32 v63, v214, v215
  v_xor_b32 v34, s46, v34
  v_xor_b32 v35, s46, v35
  v_xor_b32 v36, s46, v36
  v_xor_b32 v37, s46, v37
  s_nop 1
  v_mfma_f32_16x16x32_bf16 v[104:107], v[34:37], v[96:99], 0
  v_mfma_f32_16x16x32_bf16 v[104:107], v[34:37], v[100:103], v[104:107]
  s_waitcnt vmcnt(5)
  buffer_load_dwordx4 v[176:179], v2, s[8:11], s61 offen offset:256 nt
  s_add_u32 s61, s61, s42
  v_cvt_f32_i32 v216, v216
  v_cvt_f32_i32 v217, v217
  v_cvt_f32_i32 v218, v218
  v_cvt_f32_i32 v219, v219
  v_mov_b32_dpp v43, v74 quad_perm:[0,0,0,0] row_mask:0xf bank_mask:0xf
  v_cvt_pk_bf16_f32 v64, v216, v217
  v_cvt_pk_bf16_f32 v65, v218, v219
  v_add_f32_dpp v43, v75, v43 quad_perm:[1,1,1,1] row_mask:0xf bank_mask:0xf
  s_nop 0
  v_mfma_f32_16x16x32_bf16 v[70:73], v[62:65], v[18:21], v[26:29]
  v_add_f32_dpp v43, v76, v43 quad_perm:[2,2,2,2] row_mask:0xf bank_mask:0xf
  v_mfma_f32_16x16x32_bf16 v[70:73], v[62:65], v[22:25], v[70:73]
  s_nop 0
  v_add_f32_dpp v43, v77, v43 quad_perm:[3,3,3,3] row_mask:0xf bank_mask:0xf
  v_mul_f32 v43, s43, v43
  s_waitcnt vmcnt(5)
  buffer_load_dwordx4 v[180:183], v2, s[8:11], s62 offen offset:0 nt
  v_cvt_f32_i32 v220, v220
  v_cvt_f32_i32 v221, v221
  v_cvt_f32_i32 v222, v222
  v_cvt_f32_i32 v223, v223
  v_cvt_pk_bf16_f32 v66, v220, v221
  v_cvt_pk_bf16_f32 v67, v222, v223
  s_waitcnt vmcnt(5)
  v_cvt_f32_i32 v224, v224
  v_cvt_f32_i32 v225, v225
  v_cvt_f32_i32 v226, v226
  v_cvt_f32_i32 v227, v227
  v_mov_b32_dpp v44, v70 quad_perm:[0,0,0,0] row_mask:0xf bank_mask:0xf
  v_cvt_pk_bf16_f32 v68, v224, v225
  v_cvt_pk_bf16_f32 v69, v226, v227
  v_add_f32_dpp v44, v71, v44 quad_perm:[1,1,1,1] row_mask:0xf bank_mask:0xf
  s_nop 0
  v_mfma_f32_16x16x32_bf16 v[74:77], v[66:69], v[18:21], v[26:29]
  v_add_f32_dpp v44, v72, v44 quad_perm:[2,2,2,2] row_mask:0xf bank_mask:0xf
  v_mfma_f32_16x16x32_bf16 v[74:77], v[66:69], v[22:25], v[74:77]
  s_nop 0
  v_add_f32_dpp v44, v73, v44 quad_perm:[3,3,3,3] row_mask:0xf bank_mask:0xf
  v_mul_f32 v44, s43, v44
  v_mov_b32 v18, v96
  v_mov_b32 v19, v97
  v_mov_b32 v20, v98
  v_mov_b32 v21, v99
  v_mov_b32 v22, v100
  v_mov_b32 v23, v101
  v_mov_b32 v24, v102
  v_mov_b32 v25, v103
  v_mov_b32 v26, v104
  v_mov_b32 v27, v105
  v_mov_b32 v28, v106
  v_mov_b32 v29, v107
  s_waitcnt lgkmcnt(0)
  v_mov_b32_dpp v45, v74 quad_perm:[0,0,0,0] row_mask:0xf bank_mask:0xf
  v_max3_f32 v6, v6, v38, v39
  v_max3_f32 v6, v6, v40, v41
  v_add_f32_dpp v45, v75, v45 quad_perm:[1,1,1,1] row_mask:0xf bank_mask:0xf
  v_max3_f32 v6, v6, v42, v43
  s_nop 0
  v_add_f32_dpp v45, v76, v45 quad_perm:[2,2,2,2] row_mask:0xf bank_mask:0xf
  ds_write_b128 v9, v[38:41]
  s_nop 0
  v_add_f32_dpp v45, v77, v45 quad_perm:[3,3,3,3] row_mask:0xf bank_mask:0xf
  v_mul_f32 v45, s43, v45
  v_max3_f32 v6, v6, v44, v45
  ds_write_b128 v9, v[42:45] offset:16
  v_add_u32 v9, 512, v9
  s_cmp_eq_u32 s97, 1
  s_cselect_b32 s96, s94, s96
  s_mov_b32 s97, 0
  s_sub_u32 s98, s94, s96
  s_add_u32 s96, s96, 216
  s_sub_u32 s40, s40, 1
  s_cmp_eq_u32 s40, 0
  s_cbranch_scc1 L_klast
  s_cmp_gt_i32 s98, 0
  s_cbranch_scc1 L_kB
  s_branch L_kA
L_klast:
  s_waitcnt vmcnt(4)
  buffer_load_dwordx4 v[184:187], v2, s[8:11], s62 offen offset:256 nt
  s_add_u32 s62, s62, s47
  v_cvt_f32_i32 v164, v164
  v_cvt_f32_i32 v165, v165
  v_cvt_f32_i32 v166, v166
  v_cvt_f32_i32 v167, v167
  v_cvt_pk_bf16_f32 v62, v164, v165
  v_cvt_pk_bf16_f32 v63, v166, v167
  s_waitcnt vmcnt(4)
  buffer_load_dwordx4 v[188:191], v2, s[8:11], s63 offen offset:0 nt
  v_cvt_f32_i32 v168, v168
  v_cvt_f32_i32 v169, v169
  v_cvt_f32_i32 v170, v170
  v_cvt_f32_i32 v171, v171
  v_cvt_pk_bf16_f32 v64, v168, v169
  v_cvt_pk_bf16_f32 v65, v170, v171
  s_nop 1
  v_mfma_f32_16x16x32_bf16 v[70:73], v[62:65], v[18:21], v[26:29]
  v_mfma_f32_16x16x32_bf16 v[70:73], v[62:65], v[22:25], v[70:73]
  s_waitcnt vmcnt(4)
  buffer_load_dwordx4 v[192:195], v2, s[8:11], s63 offen offset:256 nt
  s_add_u32 s63, s63, s47
  v_cvt_f32_i32 v172, v172
  v_cvt_f32_i32 v173, v173
  v_cvt_f32_i32 v174, v174
  v_cvt_f32_i32 v175, v175
  v_cvt_pk_bf16_f32 v66, v172, v173
  v_cvt_pk_bf16_f32 v67, v174, v175
  s_waitcnt vmcnt(4)
  buffer_load_dwordx4 v[196:199], v2, s[8:11], s64 offen offset:0 nt
  v_cvt_f32_i32 v176, v176
  v_cvt_f32_i32 v177, v177
  v_cvt_f32_i32 v178, v178
  v_cvt_f32_i32 v179, v179
  v_mov_b32_dpp v38, v70 quad_perm:[0,0,0,0] row_mask:0xf bank_mask:0xf
  v_cvt_pk_bf16_f32 v68, v176, v177
  v_cvt_pk_bf16_f32 v69, v178, v179
  v_add_f32_dpp v38, v71, v38 quad_perm:[1,1,1,1] row_mask:0xf bank_mask:0xf
  s_nop 0
  v_mfma_f32_16x16x32_bf16 v[74:77], v[66:69], v[18:21], v[26:29]
  v_add_f32_dpp v38, v72, v38 quad_perm:[2,2,2,2] row_mask:0xf bank_mask:0xf
  v_mfma_f32_16x16x32_bf16 v[74:77], v[66:69], v[22:25], v[74:77]
  s_nop 0
  v_add_f32_dpp v38, v73, v38 quad_perm:[3,3,3,3] row_mask:0xf bank_mask:0xf
  v_mul_f32 v38, s43, v38
  s_waitcnt vmcnt(4)
  buffer_load_dwordx4 v[200:203], v2, s[8:11], s64 offen offset:256 nt
  s_add_u32 s64, s64, s47
  v_cvt_f32_i32 v180, v180
  v_cvt_f32_i32 v181, v181
  v_cvt_f32_i32 v182, v182
  v_cvt_f32_i32 v183, v183
  v_cvt_pk_bf16_f32 v62, v180, v181
  v_cvt_pk_bf16_f32 v63, v182, v183
  s_waitcnt vmcnt(4)
  buffer_load_dwordx4 v[204:207], v2, s[8:11], s65 offen offset:0 nt
  v_cvt_f32_i32 v184, v184
  v_cvt_f32_i32 v185, v185
  v_cvt_f32_i32 v186, v186
  v_cvt_f32_i32 v187, v187
  v_mov_b32_dpp v39, v74 quad_perm:[0,0,0,0] row_mask:0xf bank_mask:0xf
  v_cvt_pk_bf16_f32 v64, v184, v185
  v_cvt_pk_bf16_f32 v65, v186, v187
  v_add_f32_dpp v39, v75, v39 quad_perm:[1,1,1,1] row_mask:0xf bank_mask:0xf
  s_nop 0
  v_mfma_f32_16x16x32_bf16 v[70:73], v[62:65], v[18:21], v[26:29]
  v_add_f32_dpp v39, v76, v39 quad_perm:[2,2,2,2] row_mask:0xf bank_mask:0xf
  v_mfma_f32_16x16x32_bf16 v[70:73], v[62:65], v[22:25], v[70:73]
  s_nop 0
  v_add_f32_dpp v39, v77, v39 quad_perm:[3,3,3,3] row_mask:0xf bank_mask:0xf
  v_mul_f32 v39, s43, v39
  s_waitcnt vmcnt(4)
  buffer_load_dwordx4 v[208:211], v2, s[8:11], s65 offen offset:256 nt
  s_add_u32 s65, s65, s47
  v_cvt_f32_i32 v188, v188
  v_cvt_f32_i32 v189, v189
  v_cvt_f32_i32 v190, v190
  v_cvt_f32_i32 v191, v191
  v_cvt_pk_bf16_f32 v66, v188, v189
  v_cvt_pk_bf16_f32 v67, v190, v191
  s_waitcnt vmcnt(4)
  buffer_load_dwordx4 v[212:215], v2, s[8:11], s66 offen offset:0 nt
  v_cvt_f32_i32 v192, v192
  v_cvt_f32_i32 v193, v193
  v_cvt_f32_i32 v194, v194
  v_cvt_f32_i32 v195, v195
  v_mov_b32_dpp v40, v70 quad_perm:[0,0,0,0] row_mask:0xf bank_mask:0xf
  v_cvt_pk_bf16_f32 v68, v192, v193
  v_cvt_pk_bf16_f32 v69, v194, v195
  v_add_f32_dpp v40, v71, v40 quad_perm:[1,1,1,1] row_mask:0xf bank_mask:0xf
  s_nop 0
  v_mfma_f32_16x16x32_bf16 v[74:77], v[66:69], v[18:21], v[26:29]
  v_add_f32_dpp v40, v72, v40 quad_perm:[2,2,2,2] row_mask:0xf bank_mask:0xf
  v_mfma_f32_16x16x32_bf16 v[74:77], v[66:69], v[22:25], v[74:77]
  s_nop 0
  v_add_f32_dpp v40, v73, v40 quad_perm:[3,3,3,3] row_mask:0xf bank_mask:0xf
  v_mul_f32 v40, s43, v40
  s_waitcnt vmcnt(4)
  buffer_load_dwordx4 v[216:219], v2, s[8:11], s66 offen offset:256 nt
  s_add_u32 s66, s66, s47
  v_cvt_f32_i32 v196, v196
  v_cvt_f32_i32 v197, v197
  v_cvt_f32_i32 v198, v198
  v_cvt_f32_i32 v199, v199
  v_cvt_pk_bf16_f32 v62, v196, v197
  v_cvt_pk_bf16_f32 v63, v198, v199
  s_waitcnt vmcnt(4)
  buffer_load_dwordx4 v[220:223], v2, s[8:11], s67 offen offset:0 nt
  v_cvt_f32_i32 v200, v200
  v_cvt_f32_i32 v201, v201
  v_cvt_f32_i32 v202, v202
  v_cvt_f32_i32 v203, v203
  v_mov_b32_dpp v41, v74 quad_perm:[0,0,0,0] row_mask:0xf bank_mask:0xf
  v_cvt_pk_bf16_f32 v64, v200, v201
  v_cvt_pk_bf16_f32 v65, v202, v203
  v_add_f32_dpp v41, v75, v41 quad_perm:[1,1,1,1] row_mask:0xf bank_mask:0xf
  s_nop 0
  v_mfma_f32_16x16x32_bf16 v[70:73], v[62:65], v[18:21], v[26:29]
  v_add_f32_dpp v41, v76, v41 quad_perm:[2,2,2,2] row_mask:0xf bank_mask:0xf
  v_mfma_f32_16x16x32_bf16 v[70:73], v[62:65], v[22:25], v[70:73]
  s_nop 0
  v_add_f32_dpp v41, v77, v41 quad_perm:[3,3,3,3] row_mask:0xf bank_mask:0xf
  v_mul_f32 v41, s43, v41
  s_waitcnt vmcnt(4)
  buffer_load_dwordx4 v[224:227], v2, s[8:11], s67 offen offset:256 nt
  s_add_u32 s67, s67, s47
  v_cvt_f32_i32 v204, v204
  v_cvt_f32_i32 v205, v205
  v_cvt_f32_i32 v206, v206
  v_cvt_f32_i32 v207, v207
  v_cvt_pk_bf16_f32 v66, v204, v205
  v_cvt_pk_bf16_f32 v67, v206, v207
  s_waitcnt vmcnt(4)
  buffer_load_dwordx4 v[164:167], v3, s[12:15], s60 offen offset:0 nt
  v_cvt_f32_i32 v208, v208
  v_cvt_f32_i32 v209, v209
  v_cvt_f32_i32 v210, v210
  v_cvt_f32_i32 v211, v211
  v_mov_b32_dpp v42, v70 quad_perm:[0,0,0,0] row_mask:0xf bank_mask:0xf
  v_cvt_pk_bf16_f32 v68, v208, v209
  v_cvt_pk_bf16_f32 v69, v210, v211
  v_add_f32_dpp v42, v71, v42 quad_perm:[1,1,1,1] row_mask:0xf bank_mask:0xf
  s_nop 0
  v_mfma_f32_16x16x32_bf16 v[74:77], v[66:69], v[18:21], v[26:29]
  v_add_f32_dpp v42, v72, v42 quad_perm:[2,2,2,2] row_mask:0xf bank_mask:0xf
  v_mfma_f32_16x16x32_bf16 v[74:77], v[66:69], v[22:25], v[74:77]
  s_nop 0
  v_add_f32_dpp v42, v73, v42 quad_perm:[3,3,3,3] row_mask:0xf bank_mask:0xf
  v_mul_f32 v42, s43, v42
  s_waitcnt vmcnt(4)
  buffer_load_dwordx4 v[168:171], v3, s[12:15], s61 offen offset:0 nt
  v_cvt_f32_i32 v212, v212
  v_cvt_f32_i32 v213, v213
  v_cvt_f32_i32 v214, v214
  v_cvt_f32_i32 v215, v215
  v_cvt_pk_bf16_f32 v62, v212, v213
  v_cvt_pk_bf16_f32 v63, v214, v215
  s_waitcnt vmcnt(4)
  buffer_load_dwordx4 v[172:175], v3, s[12:15], s60 offen offset:256 nt
  s_add_u32 s60, s60, s41
  v_cvt_f32_i32 v216, v216
  v_cvt_f32_i32 v217, v217
  v_cvt_f32_i32 v218, v218
  v_cvt_f32_i32 v219, v219
  v_mov_b32_dpp v43, v74 quad_perm:[0,0,0,0] row_mask:0xf bank_mask:0xf
  v_cvt_pk_bf16_f32 v64, v216, v217
  v_cvt_pk_bf16_f32 v65, v218, v219
  v_add_f32_dpp v43, v75, v43 quad_perm:[1,1,1,1] row_mask:0xf bank_mask:0xf
  s_nop 0
  v_mfma_f32_16x16x32_bf16 v[70:73], v[62:65], v[18:21], v[26:29]
  v_add_f32_dpp v43, v76, v43 quad_perm:[2,2,2,2] row_mask:0xf bank_mask:0xf
  v_mfma_f32_16x16x32_bf16 v[70:73], v[62:65], v[22:25], v[70:73]
  s_nop 0
  v_add_f32_dpp v43, v77, v43 quad_perm:[3,3,3,3] row_mask:0xf bank_mask:0xf
  v_mul_f32 v43, s43, v43
  s_waitcnt vmcnt(4)
  buffer_load_dwordx4 v[176:179], v3, s[12:15], s61 offen offset:256 nt
  s_add_u32 s61, s61, s41
  v_cvt_f32_i32 v220, v220
  v_cvt_f32_i32 v221, v221
  v_cvt_f32_i32 v222, v222
  v_cvt_f32_i32 v223, v223
  v_cvt_pk_bf16_f32 v66, v220, v221
  v_cvt_pk_bf16_f32 v67, v222, v223
  s_waitcnt vmcnt(4)
  buffer_load_dwordx4 v[180:183], v3, s[12:15], s62 offen offset:0 nt
  v_cvt_f32_i32 v224, v224
  v_cvt_f32_i32 v225, v225
  v_cvt_f32_i32 v226, v226
  v_cvt_f32_i32 v227, v227
  v_mov_b32_dpp v44, v70 quad_perm:[0,0,0,0] row_mask:0xf bank_mask:0xf
  v_cvt_pk_bf16_f32 v68, v224, v225
  v_cvt_pk_bf16_f32 v69, v226, v227
  v_add_f32_dpp v44, v71, v44 quad_perm:[1,1,1,1] row_mask:0xf bank_mask:0xf
  s_nop 0
  v_mfma_f32_16x16x32_bf16 v[74:77], v[66:69], v[18:21], v[26:29]
  v_add_f32_dpp v44, v72, v44 quad_perm:[2,2,2,2] row_mask:0xf bank_mask:0xf
  v_mfma_f32_16x16x32_bf16 v[74:77], v[66:69], v[22:25], v[74:77]
  s_nop 0
  v_add_f32_dpp v44, v73, v44 quad_perm:[3,3,3,3] row_mask:0xf bank_mask:0xf
  v_mul_f32 v44, s43, v44
  s_nop 4
  v_mov_b32_dpp v45, v74 quad_perm:[0,0,0,0] row_mask:0xf bank_mask:0xf
  v_max3_f32 v6, v6, v38, v39
  v_max3_f32 v6, v6, v40, v41
  v_add_f32_dpp v45, v75, v45 quad_perm:[1,1,1,1] row_mask:0xf bank_mask:0xf
  v_max3_f32 v6, v6, v42, v43
  s_nop 0
  v_add_f32_dpp v45, v76, v45 quad_perm:[2,2,2,2] row_mask:0xf bank_mask:0xf
  ds_write_b128 v9, v[38:41]
  s_nop 0
  v_add_f32_dpp v45, v77, v45 quad_perm:[3,3,3,3] row_mask:0xf bank_mask:0xf
  v_mul_f32 v45, s43, v45
  v_max3_f32 v6, v6, v44, v45
  ds_write_b128 v9, v[42:45] offset:16
  v_add_u32 v9, 512, v9
  v_mov_b32 v95, v6
  s_nop 1
  v_permlane16_swap_b32 v6, v95
  v_max_f32 v6, v6, v95
  v_mov_b32 v95, v6
  s_nop 1
  v_permlane32_swap_b32 v6, v95
  v_max_f32 v6, v6, v95
  v_add_u32 v9, 0xffffe000, v9
  s_add_u32 s96, s96, 216
  s_waitcnt lgkmcnt(0)
  s_mov_b32 s40, 15
L_vA:
  ds_read_b128 v[38:41], v9
  ds_read_b128 v[42:45], v9 offset:16
  ds_read_b128 v[46:49], v5
  ds_read_b128 v[50:53], v5 offset:16
  ds_read_b128 v[54:57], v5 offset:32
  v_add_u32 v9, 512, v9
  v_add_u32 v5, 1280, v5
  s_waitcnt vmcnt(4)
  buffer_load_dwordx4 v[184:187], v3, s[12:15], s63 offen offset:0 nt
  v_cvt_f32_i32 v164, v164
  v_cvt_f32_i32 v165, v165
  v_cvt_f32_i32 v166, v166
  v_cvt_f32_i32 v167, v167
  s_waitcnt vmcnt(4)
  buffer_load_dwordx4 v[188:191], v3, s[12:15], s62 offen offset:256 nt
  s_add_u32 s62, s62, s41
  v_cvt_f32_i32 v168, v168
  v_cvt_f32_i32 v169, v169
  v_cvt_f32_i32 v170, v170
  v_cvt_f32_i32 v171, v171
  v_cvt_pk_bf16_f32 v96, v164, v168
  v_cvt_pk_bf16_f32 v100, v165, v169
  v_cvt_pk_bf16_f32 v104, v166, v170
  v_cvt_pk_bf16_f32 v108, v167, v171
  s_waitcnt lgkmcnt(0)
  v_sub_f32 v38, v38, v6
  v_sub_f32 v39, v39, v6
  v_sub_f32 v40, v40, v6
  v_sub_f32 v41, v41, v6
  v_sub_f32 v42, v42, v6
  v_sub_f32 v43, v43, v6
  v_sub_f32 v44, v44, v6
  v_sub_f32 v45, v45, v6
  s_waitcnt vmcnt(4)
  buffer_load_dwordx4 v[192:195], v3, s[12:15], s63 offen offset:256 nt
  s_add_u32 s63, s63, s41
  v_cvt_f32_i32 v172, v172
  v_cvt_f32_i32 v173, v173
  v_cvt_f32_i32 v174, v174
  v_cvt_f32_i32 v175, v175
  v_exp_f32 v38, v38
  v_exp_f32 v39, v39
  v_exp_f32 v40, v40
  v_exp_f32 v41, v41
  s_waitcnt vmcnt(4)
  buffer_load_dwordx4 v[196:199], v3, s[12:15], s64 offen offset:0 nt
  v_cvt_f32_i32 v176, v176
  v_cvt_f32_i32 v177, v177
  v_cvt_f32_i32 v178, v178
  v_cvt_f32_i32 v179, v179
  v_cvt_pk_bf16_f32 v112, v172, v176
  v_cvt_pk_bf16_f32 v116, v173, v177
  v_cvt_pk_bf16_f32 v120, v174, v178
  v_cvt_pk_bf16_f32 v124, v175, v179
  v_exp_f32 v42, v42
  v_exp_f32 v43, v43
  v_exp_f32 v44, v44
  v_exp_f32 v45, v45
  s_waitcnt vmcnt(4)
  buffer_load_dwordx4 v[200:203], v3, s[12:15], s65 offen offset:0 nt
  v_cvt_f32_i32 v180, v180
  v_cvt_f32_i32 v181, v181
  v_cvt_f32_i32 v182, v182
  v_cvt_f32_i32 v183, v183
  v_add_f32 v7, v7, v38
  v_add_f32 v7, v7, v39
  v_add_f32 v7, v7, v40
  v_add_f32 v7, v7, v41
  s_waitcnt vmcnt(4)
  buffer_load_dwordx4 v[204:207], v3, s[12:15], s64 offen offset:256 nt
  s_add_u32 s64, s64, s41
  v_cvt_f32_i32 v184, v184
  v_cvt_f32_i32 v185, v185
  v_cvt_f32_i32 v186, v186
  v_cvt_f32_i32 v187, v187
  v_cvt_pk_bf16_f32 v97, v180, v184
  v_cvt_pk_bf16_f32 v101, v181, v185
  v_cvt_pk_bf16_f32 v105, v182, v186
  v_cvt_pk_bf16_f32 v109, v183, v187
  v_add_f32 v7, v7, v42
  v_add_f32 v7, v7, v43
  v_add_f32 v7, v7, v44
  v_add_f32 v7, v7, v45
  s_waitcnt vmcnt(4)
  buffer_load_dwordx4 v[208:211], v3, s[12:15], s65 offen offset:256 nt
  s_add_u32 s65, s65, s41
  v_cvt_f32_i32 v188, v188
  v_cvt_f32_i32 v189, v189
  v_cvt_f32_i32 v190, v190
  v_cvt_f32_i32 v191, v191
  v_mul_f32 v38, v38, v46
  v_mul_f32 v39, v39, v47
  v_mul_f32 v40, v40, v48
  v_mul_f32 v41, v41, v49
  s_waitcnt vmcnt(4)
  buffer_load_dwordx4 v[212:215], v3, s[12:15], s66 offen offset:0 nt
  v_cvt_f32_i32 v192, v192
  v_cvt_f32_i32 v193, v193
  v_cvt_f32_i32 v194, v194
  v_cvt_f32_i32 v195, v195
  v_cvt_pk_bf16_f32 v113, v188, v192
  v_cvt_pk_bf16_f32 v117, v189, v193
  v_cvt_pk_bf16_f32 v121, v190, v194
  v_cvt_pk_bf16_f32 v125, v191, v195
  v_mul_f32 v42, v42, v50
  v_mul_f32 v43, v43, v51
  v_mul_f32 v44, v44, v52
  v_mul_f32 v45, v45, v53
  s_waitcnt vmcnt(4)
  buffer_load_dwordx4 v[216:219], v3, s[12:15], s67 offen offset:0 nt
  v_cvt_f32_i32 v196, v196
  v_cvt_f32_i32 v197, v197
  v_cvt_f32_i32 v198, v198
  v_cvt_f32_i32 v199, v199
  v_and_b32 v86, v8, v38
  v_and_b32 v87, v8, v39
  v_and_b32 v88, v8, v40
  v_and_b32 v89, v8, v41
  s_waitcnt vmcnt(4)
  buffer_load_dwordx4 v[220:223], v3, s[12:15], s66 offen offset:256 nt
  s_add_u32 s66, s66, s41
  v_cvt_f32_i32 v200, v200
  v_cvt_f32_i32 v201, v201
  v_cvt_f32_i32 v202, v202
  v_cvt_f32_i32 v203, v203
  v_cvt_pk_bf16_f32 v98, v196, v200
  v_cvt_pk_bf16_f32 v102, v197, v201
  v_cvt_pk_bf16_f32 v106, v198, v202
  v_cvt_pk_bf16_f32 v110, v199, v203
  v_and_b32 v90, v8, v42
  v_and_b32 v91, v8, v43
  v_and_b32 v92, v8, v44
  v_and_b32 v93, v8, v45
  s_waitcnt vmcnt(4)
  buffer_load_dwordx4 v[224:227], v3, s[12:15], s67 offen offset:256 nt
  s_add_u32 s67, s67, s41
  v_cvt_f32_i32 v204, v204
  v_cvt_f32_i32 v205, v205
  v_cvt_f32_i32 v206, v206
  v_cvt_f32_i32 v207, v207
  v_sub_f32 v38, v38, v86
  v_sub_f32 v39, v39, v87
  v_sub_f32 v40, v40, v88
  v_sub_f32 v41, v41, v89
  s_waitcnt vmcnt(4)
  buffer_load_dwordx4 v[164:167], v3, s[12:15], s60 offen offset:0 nt
  v_cvt_f32_i32 v208, v208
  v_cvt_f32_i32 v209, v209
  v_cvt_f32_i32 v210, v210
  v_cvt_f32_i32 v211, v211
  v_cvt_pk_bf16_f32 v114, v204, v208
  v_cvt_pk_bf16_f32 v118, v205, v209
  v_cvt_pk_bf16_f32 v122, v206, v210
  v_cvt_pk_bf16_f32 v126, v207, v211
  v_sub_f32 v42, v42, v90
  v_sub_f32 v43, v43, v91
  v_sub_f32 v44, v44, v92
  v_sub_f32 v45, v45, v93
  s_waitcnt vmcnt(4)
  buffer_load_dwordx4 v[168:171], v3, s[12:15], s61 offen offset:0 nt
  s_memrealtime s[94:95]
  v_cvt_f32_i32 v212, v212
  v_cvt_f32_i32 v213, v213
  v_cvt_f32_i32 v214, v214
  v_cvt_f32_i32 v215, v215
  v_perm_b32 v58, v39, v38, s44
  v_perm_b32 v59, v41, v40, s44
  v_perm_b32 v60, v43, v42, s44
  v_perm_b32 v61, v45, v44, s44
  s_waitcnt vmcnt(4)
  buffer_load_dwordx4 v[172:175], v3, s[12:15], s60 offen offset:256 nt
  s_add_u32 s60, s60, s41
  v_cvt_f32_i32 v216, v216
  v_cvt_f32_i32 v217, v217
  v_cvt_f32_i32 v218, v218
  v_cvt_f32_i32 v219, v219
  v_cvt_pk_bf16_f32 v99, v212, v216
  v_cvt_pk_bf16_f32 v103, v213, v217
  v_cvt_pk_bf16_f32 v107, v214, v218
  v_cvt_pk_bf16_f32 v111, v215, v219
  s_waitcnt vmcnt(4)
  buffer_load_dwordx4 v[176:179], v3, s[12:15], s61 offen offset:256 nt
  s_add_u32 s61, s61, s41
  v_cvt_f32_i32 v220, v220
  v_cvt_f32_i32 v221, v221
  v_cvt_f32_i32 v222, v222
  v_cvt_f32_i32 v223, v223
  s_waitcnt vmcnt(4)
  buffer_load_dwordx4 v[180:183], v3, s[12:15], s62 offen offset:0 nt
  v_cvt_f32_i32 v224, v224
  v_cvt_f32_i32 v225, v225
  v_cvt_f32_i32 v226, v226
  v_cvt_f32_i32 v227, v227
  v_cvt_pk_bf16_f32 v115, v220, v224
  v_cvt_pk_bf16_f32 v119, v221, v225
  v_cvt_pk_bf16_f32 v123, v222, v226
  v_cvt_pk_bf16_f32 v127, v223, v227
  v_mfma_f32_16x16x32_bf16 v[160:163], v[58:61], v[54:57], v[160:163]
  v_mfma_f32_16x16x32_bf16 v[128:131], v[58:61], v[96:99], v[128:131]
  v_mfma_f32_16x16x32_bf16 v[132:135], v[58:61], v[100:103], v[132:135]
  v_mfma_f32_16x16x32_bf16 v[136:139], v[58:61], v[104:107], v[136:139]
  v_mfma_f32_16x16x32_bf16 v[140:143], v[58:61], v[108:111], v[140:143]
  v_mfma_f32_16x16x32_bf16 v[144:147], v[58:61], v[112:115], v[144:147]
  v_mfma_f32_16x16x32_bf16 v[148:151], v[58:61], v[116:119], v[148:151]
  v_mfma_f32_16x16x32_bf16 v[152:155], v[58:61], v[120:123], v[152:155]
  v_mfma_f32_16x16x32_bf16 v[156:159], v[58:61], v[124:127], v[156:159]
  s_waitcnt lgkmcnt(0)
  s_cmp_eq_u32 s97, 1
  s_cselect_b32 s96, s94, s96
  s_mov_b32 s97, 0
  s_sub_u32 s98, s94, s96
  s_add_u32 s96, s96, 216
  s_sub_u32 s40, s40, 1
  s_cmp_eq_u32 s40, 0
  s_cbranch_scc1 L_vlast
  s_cmp_gt_i32 s98, 0
  s_cbranch_scc0 L_vA
L_vB:
  ds_read_b128 v[38:41], v9
  ds_read_b128 v[42:45], v9 offset:16
  ds_read_b128 v[46:49], v5
  ds_read_b128 v[50:53], v5 offset:16
  ds_read_b128 v[54:57], v5 offset:32
  v_add_u32 v9, 512, v9
  v_add_u32 v5, 1280, v5
  s_waitcnt vmcnt(4)
  buffer_load_dwordx4 v[184:187], v3, s[12:15], s63 offen offset:0 nt
  buffer_load_dwordx4 v[188:191], v3, s[12:15], s62 offen offset:256 nt
  s_add_u32 s62, s62, s41
  v_cvt_f32_i32 v164, v164
  v_cvt_f32_i32 v165, v165
  v_cvt_f32_i32 v166, v166
  v_cvt_f32_i32 v167, v167
  s_waitcnt vmcnt(5)
  buffer_load_dwordx4 v[192:195], v3, s[12:15], s63 offen offset:256 nt
  s_add_u32 s63, s63, s41
  v_cvt_f32_i32 v168, v168
  v_cvt_f32_i32 v169, v169
  v_cvt_f32_i32 v170, v170
  v_cvt_f32_i32 v171, v171
  v_cvt_pk_bf16_f32 v96, v164, v168
  v_cvt_pk_bf16_f32 v100, v165, v169
  v_cvt_pk_bf16_f32 v104, v166, v170
  v_cvt_pk_bf16_f32 v108, v167, v171
  s_waitcnt lgkmcnt(0)
  v_sub_f32 v38, v38, v6
  v_sub_f32 v39, v39, v6
  v_sub_f32 v40, v40, v6
  v_sub_f32 v41, v41, v6
  v_sub_f32 v42, v42, v6
  v_sub_f32 v43, v43, v6
  v_sub_f32 v44, v44, v6
  v_sub_f32 v45, v45, v6
  s_waitcnt vmcnt(5)
  buffer_load_dwordx4 v[196:199], v3, s[12:15], s64 offen offset:0 nt
  v_cvt_f32_i32 v172, v172
  v_cvt_f32_i32 v173, v173
  v_cvt_f32_i32 v174, v174
  v_cvt_f32_i32 v175, v175
  v_exp_f32 v38, v38
  v_exp_f32 v39, v39
  v_exp_f32 v40, v40
  v_exp_f32 v41, v41
  s_waitcnt vmcnt(5)
  buffer_load_dwordx4 v[200:203], v3, s[12:15], s65 offen offset:0 nt
  v_cvt_f32_i32 v176, v176
  v_cvt_f32_i32 v177, v177
  v_cvt_f32_i32 v178, v178
  v_cvt_f32_i32 v179, v179
  v_cvt_pk_bf16_f32 v112, v172, v176
  v_cvt_pk_bf16_f32 v116, v173, v177
  v_cvt_pk_bf16_f32 v120, v174, v178
  v_cvt_pk_bf16_f32 v124, v175, v179
  v_exp_f32 v42, v42
  v_exp_f32 v43, v43
  v_exp_f32 v44, v44
  v_exp_f32 v45, v45
  s_waitcnt vmcnt(5)
  buffer_load_dwordx4 v[204:207], v3, s[12:15], s64 offen offset:256 nt
  s_add_u32 s64, s64, s41
  v_cvt_f32_i32 v180, v180
  v_cvt_f32_i32 v181, v181
  v_cvt_f32_i32 v182, v182
  v_cvt_f32_i32 v183, v183
  v_add_f32 v7, v7, v38
  v_add_f32 v7, v7, v39
  v_add_f32 v7, v7, v40
  v_add_f32 v7, v7, v41
  s_waitcnt vmcnt(5)
  buffer_load_dwordx4 v[208:211], v3, s[12:15], s65 offen offset:256 nt
  s_add_u32 s65, s65, s41
  v_cvt_f32_i32 v184, v184
  v_cvt_f32_i32 v185, v185
  v_cvt_f32_i32 v186, v186
  v_cvt_f32_i32 v187, v187
  v_cvt_pk_bf16_f32 v97, v180, v184
  v_cvt_pk_bf16_f32 v101, v181, v185
  v_cvt_pk_bf16_f32 v105, v182, v186
  v_cvt_pk_bf16_f32 v109, v183, v187
  v_add_f32 v7, v7, v42
  v_add_f32 v7, v7, v43
  v_add_f32 v7, v7, v44
  v_add_f32 v7, v7, v45
  s_waitcnt vmcnt(5)
  buffer_load_dwordx4 v[212:215], v3, s[12:15], s66 offen offset:0 nt
  v_cvt_f32_i32 v188, v188
  v_cvt_f32_i32 v189, v189
  v_cvt_f32_i32 v190, v190
  v_cvt_f32_i32 v191, v191
  v_mul_f32 v38, v38, v46
  v_mul_f32 v39, v39, v47
  v_mul_f32 v40, v40, v48
  v_mul_f32 v41, v41, v49
  s_waitcnt vmcnt(5)
  buffer_load_dwordx4 v[216:219], v3, s[12:15], s67 offen offset:0 nt
  v_cvt_f32_i32 v192, v192
  v_cvt_f32_i32 v193, v193
  v_cvt_f32_i32 v194, v194
  v_cvt_f32_i32 v195, v195
  v_cvt_pk_bf16_f32 v113, v188, v192
  v_cvt_pk_bf16_f32 v117, v189, v193
  v_cvt_pk_bf16_f32 v121, v190, v194
  v_cvt_pk_bf16_f32 v125, v191, v195
  v_mul_f32 v42, v42, v50
  v_mul_f32 v43, v43, v51
  v_mul_f32 v44, v44, v52
  v_mul_f32 v45, v45, v53
  s_waitcnt vmcnt(5)
  buffer_load_dwordx4 v[220:223], v3, s[12:15], s66 offen offset:256 nt
  s_add_u32 s66, s66, s41
  v_cvt_f32_i32 v196, v196
  v_cvt_f32_i32 v197, v197
  v_cvt_f32_i32 v198, v198
  v_cvt_f32_i32 v199, v199
  v_and_b32 v86, v8, v38
  v_and_b32 v87, v8, v39
  v_and_b32 v88, v8, v40
  v_and_b32 v89, v8, v41
  s_waitcnt vmcnt(5)
  buffer_load_dwordx4 v[224:227], v3, s[12:15], s67 offen offset:256 nt
  s_add_u32 s67, s67, s41
  v_cvt_f32_i32 v200, v200
  v_cvt_f32_i32 v201, v201
  v_cvt_f32_i32 v202, v202
  v_cvt_f32_i32 v203, v203
  v_cvt_pk_bf16_f32 v98, v196, v200
  v_cvt_pk_bf16_f32 v102, v197, v201
  v_cvt_pk_bf16_f32 v106, v198, v202
  v_cvt_pk_bf16_f32 v110, v199, v203
  v_and_b32 v90, v8, v42
  v_and_b32 v91, v8, v43
  v_and_b32 v92, v8, v44
  v_and_b32 v93, v8, v45
  s_waitcnt vmcnt(5)
  buffer_load_dwordx4 v[164:167], v3, s[12:15], s60 offen offset:0 nt
  v_cvt_f32_i32 v204, v204
  v_cvt_f32_i32 v205, v205
  v_cvt_f32_i32 v206, v206
  v_cvt_f32_i32 v207, v207
  v_sub_f32 v38, v38, v86
  v_sub_f32 v39, v39, v87
  v_sub_f32 v40, v40, v88
  v_sub_f32 v41, v41, v89
  s_waitcnt vmcnt(5)
  buffer_load_dwordx4 v[168:171], v3, s[12:15], s61 offen offset:0 nt
  v_cvt_f32_i32 v208, v208
  v_cvt_f32_i32 v209, v209
  v_cvt_f32_i32 v210, v210
  v_cvt_f32_i32 v211, v211
  v_cvt_pk_bf16_f32 v114, v204, v208
  v_cvt_pk_bf16_f32 v118, v205, v209
  v_cvt_pk_bf16_f32 v122, v206, v210
  v_cvt_pk_bf16_f32 v126, v207, v211
  v_sub_f32 v42, v42, v90
  v_sub_f32 v43, v43, v91
  v_sub_f32 v44, v44, v92
  v_sub_f32 v45, v45, v93
  s_waitcnt vmcnt(5)
  buffer_load_dwordx4 v[172:175], v3, s[12:15], s60 offen offset:256 nt
  s_add_u32 s60, s60, s41
  s_memrealtime s[94:95]
  v_cvt_f32_i32 v212, v212
  v_cvt_f32_i32 v213, v213
  v_cvt_f32_i32 v214, v214
  v_cvt_f32_i32 v215, v215
  v_perm_b32 v58, v39, v38, s44
  v_perm_b32 v59, v41, v40, s44
  v_perm_b32 v60, v43, v42, s44
  v_perm_b32 v61, v45, v44, s44
  s_waitcnt vmcnt(5)
  buffer_load_dwordx4 v[176:179], v3, s[12:15], s61 offen offset:256 nt
  s_add_u32 s61, s61, s41
  v_cvt_f32_i32 v216, v216
  v_cvt_f32_i32 v217, v217
  v_cvt_f32_i32 v218, v218
  v_cvt_f32_i32 v219, v219
  v_cvt_pk_bf16_f32 v99, v212, v216
  v_cvt_pk_bf16_f32 v103, v213, v217
  v_cvt_pk_bf16_f32 v107, v214, v218
  v_cvt_pk_bf16_f32 v111, v215, v219
  s_waitcnt vmcnt(5)
  buffer_load_dwordx4 v[180:183], v3, s[12:15], s62 offen offset:0 nt
  v_cvt_f32_i32 v220, v220
  v_cvt_f32_i32 v221, v221
  v_cvt_f32_i32 v222, v222
  v_cvt_f32_i32 v223, v223
  s_waitcnt vmcnt(5)
  v_cvt_f32_i32 v224, v224
  v_cvt_f32_i32 v225, v225
  v_cvt_f32_i32 v226, v226
  v_cvt_f32_i32 v227, v227
  v_cvt_pk_bf16_f32 v115, v220, v224
  v_cvt_pk_bf16_f32 v119, v221, v225
  v_cvt_pk_bf16_f32 v123, v222, v226
  v_cvt_pk_bf16_f32 v127, v223, v227
  v_mfma_f32_16x16x32_bf16 v[160:163], v[58:61], v[54:57], v[160:163]
  v_mfma_f32_16x16x32_bf16 v[128:131], v[58:61], v[96:99], v[128:131]
  v_mfma_f32_16x16x32_bf16 v[132:135], v[58:61], v[100:103], v[132:135]
  v_mfma_f32_16x16x32_bf16 v[136:139], v[58:61], v[104:107], v[136:139]
  v_mfma_f32_16x16x32_bf16 v[140:143], v[58:61], v[108:111], v[140:143]
  v_mfma_f32_16x16x32_bf16 v[144:147], v[58:61], v[112:115], v[144:147]
  v_mfma_f32_16x16x32_bf16 v[148:151], v[58:61], v[116:119], v[148:151]
  v_mfma_f32_16x16x32_bf16 v[152:155], v[58:61], v[120:123], v[152:155]
  v_mfma_f32_16x16x32_bf16 v[156:159], v[58:61], v[124:127], v[156:159]
  s_waitcnt lgkmcnt(0)
  s_cmp_eq_u32 s97, 1
  s_cselect_b32 s96, s94, s96
  s_mov_b32 s97, 0
  s_sub_u32 s98, s94, s96
  s_add_u32 s96, s96, 216
  s_sub_u32 s40, s40, 1
  s_cmp_eq_u32 s40, 0
  s_cbranch_scc1 L_vlast
  s_cmp_gt_i32 s98, 0
  s_cbranch_scc1 L_vB
  s_branch L_vA
L_vlast:
  ds_read_b128 v[38:41], v9
  ds_read_b128 v[42:45], v9 offset:16
  ds_read_b128 v[46:49], v5
  ds_read_b128 v[50:53], v5 offset:16
  ds_read_b128 v[54:57], v5 offset:32
  s_waitcnt vmcnt(4)
  buffer_load_dwordx4 v[184:187], v3, s[12:15], s63 offen offset:0 nt
  buffer_load_dwordx4 v[188:191], v3, s[12:15], s62 offen offset:256 nt
  buffer_load_dwordx4 v[192:195], v3, s[12:15], s63 offen offset:256 nt
  buffer_load_dwordx4 v[196:199], v3, s[12:15], s64 offen offset:0 nt
  buffer_load_dwordx4 v[200:203], v3, s[12:15], s65 offen offset:0 nt
  buffer_load_dwordx4 v[204:207], v3, s[12:15], s64 offen offset:256 nt
  buffer_load_dwordx4 v[208:211], v3, s[12:15], s65 offen offset:256 nt
  buffer_load_dwordx4 v[212:215], v3, s[12:15], s66 offen offset:0 nt
  v_cvt_f32_i32 v164, v164
  v_cvt_f32_i32 v165, v165
  v_cvt_f32_i32 v166, v166
  v_cvt_f32_i32 v167, v167
  s_waitcnt vmcnt(11)
  buffer_load_dwordx4 v[216:219], v3, s[12:15], s67 offen offset:0 nt
  v_cvt_f32_i32 v168, v168
  v_cvt_f32_i32 v169, v169
  v_cvt_f32_i32 v170, v170
  v_cvt_f32_i32 v171, v171
  v_cvt_pk_bf16_f32 v96, v164, v168
  v_cvt_pk_bf16_f32 v100, v165, v169
  v_cvt_pk_bf16_f32 v104, v166, v170
  v_cvt_pk_bf16_f32 v108, v167, v171
  s_waitcnt lgkmcnt(0)
  v_sub_f32 v38, v38, v6
  v_sub_f32 v39, v39, v6
  v_sub_f32 v40, v40, v6
  v_sub_f32 v41, v41, v6
  v_sub_f32 v42, v42, v6
  v_sub_f32 v43, v43, v6
  v_sub_f32 v44, v44, v6
  v_sub_f32 v45, v45, v6
  s_waitcnt vmcnt(11)
  buffer_load_dwordx4 v[220:223], v3, s[12:15], s66 offen offset:256 nt
  v_cvt_f32_i32 v172, v172
  v_cvt_f32_i32 v173, v173
  v_cvt_f32_i32 v174, v174
  v_cvt_f32_i32 v175, v175
  v_exp_f32 v38, v38
  v_exp_f32 v39, v39
  v_exp_f32 v40, v40
  v_exp_f32 v41, v41
  s_waitcnt vmcnt(11)
  buffer_load_dwordx4 v[224:227], v3, s[12:15], s67 offen offset:256 nt
  v_cvt_f32_i32 v176, v176
  v_cvt_f32_i32 v177, v177
  v_cvt_f32_i32 v178, v178
  v_cvt_f32_i32 v179, v179
  v_cvt_pk_bf16_f32 v112, v172, v176
  v_cvt_pk_bf16_f32 v116, v173, v177
  v_cvt_pk_bf16_f32 v120, v174, v178
  v_cvt_pk_bf16_f32 v124, v175, v179
  v_exp_f32 v42, v42
  v_exp_f32 v43, v43
  v_exp_f32 v44, v44
  v_exp_f32 v45, v45
  s_waitcnt vmcnt(11)
  v_cvt_f32_i32 v180, v180
  v_cvt_f32_i32 v181, v181
  v_cvt_f32_i32 v182, v182
  v_cvt_f32_i32 v183, v183
  v_add_f32 v7, v7, v38
  v_add_f32 v7, v7, v39
  v_add_f32 v7, v7, v40
  v_add_f32 v7, v7, v41
  s_waitcnt vmcnt(10)
  v_cvt_f32_i32 v184, v184
  v_cvt_f32_i32 v185, v185
  v_cvt_f32_i32 v186, v186
  v_cvt_f32_i32 v187, v187
  v_cvt_pk_bf16_f32 v97, v180, v184
  v_cvt_pk_bf16_f32 v101, v181, v185
  v_cvt_pk_bf16_f32 v105, v182, v186
  v_cvt_pk_bf16_f32 v109, v183, v187
  v_add_f32 v7, v7, v42
  v_add_f32 v7, v7, v43
  v_add_f32 v7, v7, v44
  v_add_f32 v7, v7, v45
  s_waitcnt vmcnt(9)
  v_cvt_f32_i32 v188, v188
  v_cvt_f32_i32 v189, v189
  v_cvt_f32_i32 v190, v190
  v_cvt_f32_i32 v191, v191
  v_mul_f32 v38, v38, v46
  v_mul_f32 v39, v39, v47
  v_mul_f32 v40, v40, v48
  v_mul_f32 v41, v41, v49
  s_waitcnt vmcnt(8)
  v_cvt_f32_i32 v192, v192
  v_cvt_f32_i32 v193, v193
  v_cvt_f32_i32 v194, v194
  v_cvt_f32_i32 v195, v195
  v_cvt_pk_bf16_f32 v113, v188, v192
  v_cvt_pk_bf16_f32 v117, v189, v193
  v_cvt_pk_bf16_f32 v121, v190, v194
  v_cvt_pk_bf16_f32 v125, v191, v195
  v_mul_f32 v42, v42, v50
  v_mul_f32 v43, v43, v51
  v_mul_f32 v44, v44, v52
  v_mul_f32 v45, v45, v53
  v_and_b32 v78, 15, v1
  v_lshrrev_b32 v79, 4, v1
  v_lshlrev_b32 v85, 3, v78
  v_lshlrev_b32 v78, 4, v78
  v_lshl_add_u32 v78, v79, 9, v78
  s_lshl_b32 s48, s36, 11
  s_add_u32 s48, s48, 54528
  v_add_u32 v78, s48, v78
  v_lshrrev_b32 v80, 2, v1
  v_lshlrev_b32 v80, 3, v80
  s_lshl_b32 s48, s36, 5
  s_add_u32 s48, s48, 62720
  v_add_u32 v80, s48, v80
  s_waitcnt vmcnt(7)
  v_cvt_f32_i32 v196, v196
  v_cvt_f32_i32 v197, v197
  v_cvt_f32_i32 v198, v198
  v_cvt_f32_i32 v199, v199
  v_and_b32 v86, v8, v38
  v_and_b32 v87, v8, v39
  v_and_b32 v88, v8, v40
  v_and_b32 v89, v8, v41
  s_waitcnt vmcnt(6)
  v_cvt_f32_i32 v200, v200
  v_cvt_f32_i32 v201, v201
  v_cvt_f32_i32 v202, v202
  v_cvt_f32_i32 v203, v203
  v_cvt_pk_bf16_f32 v98, v196, v200
  v_cvt_pk_bf16_f32 v102, v197, v201
  v_cvt_pk_bf16_f32 v106, v198, v202
  v_cvt_pk_bf16_f32 v110, v199, v203
  v_and_b32 v90, v8, v42
  v_and_b32 v91, v8, v43
  v_and_b32 v92, v8, v44
  v_and_b32 v93, v8, v45
  s_lshl_b32 s48, s36, 3
  s_add_u32 s48, s48, 62720
  v_mov_b32 v81, s48
  s_lshl_b32 s48, s36, 9
  s_add_u32 s48, s48, 54528
  v_lshlrev_b32 v83, 3, v1
  v_add_u32 v82, s48, v83
  v_mov_b32 v84, 0
  v_mov_b32 v95, v7
  s_nop 1
  v_permlane16_swap_b32 v7, v95
  v_add_f32 v7, v7, v95
  v_mov_b32 v95, v7
  s_nop 1
  v_permlane32_swap_b32 v7, v95
  v_add_f32 v7, v7, v95
  s_waitcnt vmcnt(5)
  v_cvt_f32_i32 v204, v204
  v_cvt_f32_i32 v205, v205
  v_cvt_f32_i32 v206, v206
  v_cvt_f32_i32 v207, v207
  v_sub_f32 v38, v38, v86
  v_sub_f32 v39, v39, v87
  v_sub_f32 v40, v40, v88
  v_sub_f32 v41, v41, v89
  s_waitcnt vmcnt(4)
  v_cvt_f32_i32 v208, v208
  v_cvt_f32_i32 v209, v209
  v_cvt_f32_i32 v210, v210
  v_cvt_f32_i32 v211, v211
  v_cvt_pk_bf16_f32 v114, v204, v208
  v_cvt_pk_bf16_f32 v118, v205, v209
  v_cvt_pk_bf16_f32 v122, v206, v210
  v_cvt_pk_bf16_f32 v126, v207, v211
  v_sub_f32 v42, v42, v90
  v_sub_f32 v43, v43, v91
  v_sub_f32 v44, v44, v92
  v_sub_f32 v45, v45, v93
  s_mov_b32 s8, s34
  s_mov_b32 s9, s35
  s_mov_b32 s10, 0x100000
  s_mov_b32 s11, 0x20000
  s_lshl_b32 s48, s2, 2
  s_add_u32 s48, s48, s36
  s_lshl_b32 s48, s48, 9
  s_lshl_b32 s49, s37, 2
  s_add_u32 s49, s49, s36
  s_lshl_b32 s54, s49, 8
  s_lshl_b32 s49, s49, 7
  s_add_u32 s49, s49, 0x80000
  s_and_b32 s50, s2, 15
  s_lshl_b32 s50, s50, 3
  s_add_u32 s50, s50, s49
  s_lshl_b32 s52, s37, 6
  s_add_u32 s52, s52, s36
  s_lshl_b32 s52, s52, 9
  s_lshl_b32 s51, s37, 4
  s_waitcnt vmcnt(3)
  v_cvt_f32_i32 v212, v212
  v_cvt_f32_i32 v213, v213
  v_cvt_f32_i32 v214, v214
  v_cvt_f32_i32 v215, v215
  v_perm_b32 v58, v39, v38, s44
  v_perm_b32 v59, v41, v40, s44
  v_perm_b32 v60, v43, v42, s44
  v_perm_b32 v61, v45, v44, s44
  s_waitcnt vmcnt(2)
  v_cvt_f32_i32 v216, v216
  v_cvt_f32_i32 v217, v217
  v_cvt_f32_i32 v218, v218
  v_cvt_f32_i32 v219, v219
  v_cvt_pk_bf16_f32 v99, v212, v216
  v_cvt_pk_bf16_f32 v103, v213, v217
  v_cvt_pk_bf16_f32 v107, v214, v218
  v_cvt_pk_bf16_f32 v111, v215, v219
  v_mfma_f32_16x16x32_bf16 v[160:163], v[58:61], v[54:57], v[160:163]
  v_mfma_f32_16x16x32_bf16 v[128:131], v[58:61], v[96:99], v[128:131]
  v_mfma_f32_16x16x32_bf16 v[132:135], v[58:61], v[100:103], v[132:135]
  v_mfma_f32_16x16x32_bf16 v[136:139], v[58:61], v[104:107], v[136:139]
  v_mfma_f32_16x16x32_bf16 v[140:143], v[58:61], v[108:111], v[140:143]
  s_waitcnt vmcnt(1)
  v_cvt_f32_i32 v220, v220
  v_cvt_f32_i32 v221, v221
  v_cvt_f32_i32 v222, v222
  v_cvt_f32_i32 v223, v223
  s_waitcnt vmcnt(0)
  v_cvt_f32_i32 v224, v224
  v_cvt_f32_i32 v225, v225
  v_cvt_f32_i32 v226, v226
  v_cvt_f32_i32 v227, v227
  v_cvt_pk_bf16_f32 v115, v220, v224
  v_cvt_pk_bf16_f32 v119, v221, v225
  v_cvt_pk_bf16_f32 v123, v222, v226
  v_cvt_pk_bf16_f32 v127, v223, v227
  v_mfma_f32_16x16x32_bf16 v[144:147], v[58:61], v[112:115], v[144:147]
  v_mfma_f32_16x16x32_bf16 v[148:151], v[58:61], v[116:119], v[148:151]
  v_mfma_f32_16x16x32_bf16 v[152:155], v[58:61], v[120:123], v[152:155]
  v_mfma_f32_16x16x32_bf16 v[156:159], v[58:61], v[124:127], v[156:159]
L_epi:
  v_add_f32 v95, v160, v161
  v_add_f32 v38, v128, v129
  v_sub_f32 v38, v38, v95
  v_add_f32 v39, v132, v133
  v_sub_f32 v39, v39, v95
  v_add_f32 v40, v136, v137
  v_sub_f32 v40, v40, v95
  v_add_f32 v41, v140, v141
  v_sub_f32 v41, v41, v95
  ds_write_b128 v78, v[38:41]
  v_add_f32 v42, v144, v145
  v_sub_f32 v42, v42, v95
  v_add_f32 v43, v148, v149
  v_sub_f32 v43, v43, v95
  v_add_f32 v44, v152, v153
  v_sub_f32 v44, v44, v95
  v_add_f32 v45, v156, v157
  v_sub_f32 v45, v45, v95
  ds_write_b128 v78, v[42:45] offset:256
  s_mov_b64 exec, 0x1111
  ds_write_b64 v80, v[6:7]
  s_mov_b64 exec, -1
  s_waitcnt lgkmcnt(0)
  s_barrier
  ds_read_b64 v[86:87], v81 offset:0
  ds_read_b64 v[88:89], v81 offset:32
  ds_read_b64 v[90:91], v81 offset:64
  ds_read_b64 v[92:93], v81 offset:96
  ds_read_b64 v[38:39], v82 offset:0
  ds_read_b64 v[40:41], v82 offset:2048
  ds_read_b64 v[42:43], v82 offset:4096
  ds_read_b64 v[44:45], v82 offset:6144
  s_waitcnt lgkmcnt(4)
  v_max3_f32 v30, v86, v88, v90
  v_max_f32 v30, v30, v92
  v_sub_f32 v86, v86, v30
  v_sub_f32 v88, v88, v30
  v_sub_f32 v90, v90, v30
  v_sub_f32 v92, v92, v30
  v_exp_f32 v86, v86
  v_exp_f32 v88, v88
  v_exp_f32 v90, v90
  v_exp_f32 v92, v92
  s_waitcnt lgkmcnt(0)
  v_mul_f32 v34, v86, v38
  v_mul_f32 v35, v86, v39
  v_fma_f32 v34, v88, v40, v34
  v_fma_f32 v35, v88, v41, v35
  v_fma_f32 v34, v90, v42, v34
  v_fma_f32 v35, v90, v43, v35
  v_fma_f32 v34, v92, v44, v34
  v_fma_f32 v35, v92, v45, v35
  buffer_store_dwordx2 v[34:35], v83, s[8:11], s48 offen sc1
  v_mul_f32 v31, v86, v87
  v_fma_f32 v31, v88, v89, v31
  v_fma_f32 v31, v90, v91, v31
  v_fma_f32 v31, v92, v93, v31
  s_mov_b64 exec, 1
  buffer_store_dwordx2 v[30:31], v84, s[8:11], s50 offen sc1
  s_mov_b64 exec, -1
  v_mov_b32 v79, s51
  v_mov_b32 v80, 1
  v_mov_b32 v82, 62848
  s_waitcnt vmcnt(0)
  s_barrier
  s_cmp_eq_u32 s36, 0
  s_cbranch_scc0 L_noatom
  s_mov_b64 exec, 1
  global_atomic_add v81, v79, v80, s[32:33] sc0
  s_waitcnt vmcnt(0)
  ds_write_b32 v82, v81
  s_waitcnt lgkmcnt(0)
  s_mov_b64 exec, -1
L_noatom:
  s_barrier
  ds_read_b32 v81, v82
  s_waitcnt lgkmcnt(0)
  v_readfirstlane_b32 s51, v81
  s_cmp_eq_u32 s51, 15
  s_cbranch_scc0 L_end
  buffer_load_dwordx2 v[30:31], v85, s[8:11], s49 offen sc1
  buffer_load_dwordx2 v[96:97], v83, s[8:11], s52 offen sc1
  s_add_u32 s52, s52, 2048
  buffer_load_dwordx2 v[98:99], v83, s[8:11], s52 offen sc1
  s_add_u32 s52, s52, 2048
  buffer_load_dwordx2 v[100:101], v83, s[8:11], s52 offen sc1
  s_add_u32 s52, s52, 2048
  buffer_load_dwordx2 v[102:103], v83, s[8:11], s52 offen sc1
  s_add_u32 s52, s52, 2048
  buffer_load_dwordx2 v[104:105], v83, s[8:11], s52 offen sc1
  s_add_u32 s52, s52, 2048
  buffer_load_dwordx2 v[106:107], v83, s[8:11], s52 offen sc1
  s_add_u32 s52, s52, 2048
  buffer_load_dwordx2 v[108:109], v83, s[8:11], s52 offen sc1
  s_add_u32 s52, s52, 2048
  buffer_load_dwordx2 v[110:111], v83, s[8:11], s52 offen sc1
  s_add_u32 s52, s52, 2048
  buffer_load_dwordx2 v[112:113], v83, s[8:11], s52 offen sc1
  s_add_u32 s52, s52, 2048
  buffer_load_dwordx2 v[114:115], v83, s[8:11], s52 offen sc1
  s_add_u32 s52, s52, 2048
  buffer_load_dwordx2 v[116:117], v83, s[8:11], s52 offen sc1
  s_add_u32 s52, s52, 2048
  buffer_load_dwordx2 v[118:119], v83, s[8:11], s52 offen sc1
  s_add_u32 s52, s52, 2048
  buffer_load_dwordx2 v[120:121], v83, s[8:11], s52 offen sc1
  s_add_u32 s52, s52, 2048
  buffer_load_dwordx2 v[122:123], v83, s[8:11], s52 offen sc1
  s_add_u32 s52, s52, 2048
  buffer_load_dwordx2 v[124:125], v83, s[8:11], s52 offen sc1
  s_add_u32 s52, s52, 2048
  buffer_load_dwordx2 v[126:127], v83, s[8:11], s52 offen sc1
  s_mov_b32 s12, s30
  s_mov_b32 s13, s31
  s_mov_b32 s14, 16384
  s_mov_b32 s15, 0x20000
  v_lshlrev_b32 v79, 2, v1
  s_waitcnt vmcnt(16)
  v_mov_b32 v86, v30
  s_nop 1
  v_max_f32_dpp v86, v86, v86 row_ror:8 row_mask:0xf bank_mask:0xf
  s_nop 1
  v_max_f32_dpp v86, v86, v86 row_ror:4 row_mask:0xf bank_mask:0xf
  s_nop 1
  v_max_f32_dpp v86, v86, v86 row_ror:2 row_mask:0xf bank_mask:0xf
  s_nop 1
  v_max_f32_dpp v86, v86, v86 row_ror:1 row_mask:0xf bank_mask:0xf
  v_sub_f32 v87, v30, v86
  v_exp_f32 v87, v87
  s_nop 0
  v_mul_f32 v88, v87, v31
  v_readlane_b32 s76, v87, 0
  v_readlane_b32 s77, v87, 1
  v_add_f32_dpp v88, v88, v88 row_ror:8 row_mask:0xf bank_mask:0xf
  v_readlane_b32 s78, v87, 2
  v_readlane_b32 s79, v87, 3
  v_readlane_b32 s80, v87, 4
  v_readlane_b32 s81, v87, 5
  v_add_f32_dpp v88, v88, v88 row_ror:4 row_mask:0xf bank_mask:0xf
  v_readlane_b32 s82, v87, 6
  v_readlane_b32 s83, v87, 7
  v_readlane_b32 s84, v87, 8
  v_readlane_b32 s85, v87, 9
  v_add_f32_dpp v88, v88, v88 row_ror:2 row_mask:0xf bank_mask:0xf
  v_readlane_b32 s86, v87, 10
  v_readlane_b32 s87, v87, 11
  v_readlane_b32 s88, v87, 12
  v_readlane_b32 s89, v87, 13
  v_add_f32_dpp v88, v88, v88 row_ror:1 row_mask:0xf bank_mask:0xf
  v_readlane_b32 s90, v87, 14
  v_readlane_b32 s91, v87, 15
  v_rcp_f32 v88, v88
  s_waitcnt vmcnt(0)
  v_mul_f32 v34, s76, v96
  v_mul_f32 v35, s76, v97
  v_fma_f32 v34, s77, v98, v34
  v_fma_f32 v35, s77, v99, v35
  v_fma_f32 v34, s78, v100, v34
  v_fma_f32 v35, s78, v101, v35
  v_fma_f32 v34, s79, v102, v34
  v_fma_f32 v35, s79, v103, v35
  v_fma_f32 v34, s80, v104, v34
  v_fma_f32 v35, s80, v105, v35
  v_fma_f32 v34, s81, v106, v34
  v_fma_f32 v35, s81, v107, v35
  v_fma_f32 v34, s82, v108, v34
  v_fma_f32 v35, s82, v109, v35
  v_fma_f32 v34, s83, v110, v34
  v_fma_f32 v35, s83, v111, v35
  v_fma_f32 v34, s84, v112, v34
  v_fma_f32 v35, s84, v113, v35
  v_fma_f32 v34, s85, v114, v34
  v_fma_f32 v35, s85, v115, v35
  v_fma_f32 v34, s86, v116, v34
  v_fma_f32 v35, s86, v117, v35
  v_fma_f32 v34, s87, v118, v34
  v_fma_f32 v35, s87, v119, v35
  v_fma_f32 v34, s88, v120, v34
  v_fma_f32 v35, s88, v121, v35
  v_fma_f32 v34, s89, v122, v34
  v_fma_f32 v35, s89, v123, v35
  v_fma_f32 v34, s90, v124, v34
  v_fma_f32 v35, s90, v125, v35
  v_fma_f32 v34, s91, v126, v34
  v_fma_f32 v35, s91, v127, v35
  v_mul_f32 v34, v34, v88
  v_mul_f32 v35, v35, v88
  v_cvt_pk_bf16_f32 v34, v34, v35
  buffer_store_dword v34, v79, s[12:15], s54 offen
L_end:
  s_endpgm
.section .rodata,"a"
.p2align 6
.amdhsa_kernel standalone__kv_cache_quant_int4_int2_kv_with_per_channel_or_per_token_scales__decode_kernel
  .amdhsa_next_free_vgpr 228
  .amdhsa_next_free_sgpr 99
  .amdhsa_accum_offset 228
  .amdhsa_group_segment_fixed_size 0
  .amdhsa_kernarg_size 80
  .amdhsa_user_sgpr_count 2
  .amdhsa_user_sgpr_kernarg_segment_ptr 1
  .amdhsa_system_sgpr_workgroup_id_x 1
  .amdhsa_float_denorm_mode_32 3
.end_amdhsa_kernel
```
